```python
import torch

def _softmax(x, axis=-1):
    return torch.softmax(x, dim=axis)
def _gelu(x):
    return torch.nn.functional.gelu(x, approximate="tanh")
def _silu(x):
    return torch.nn.functional.silu(x)
def _sigmoid(x):
    return torch.sigmoid(x)
def _layernorm(x, axis=-1, eps=1e-5):
    m = x.mean(dim=axis, keepdim=True)
    v = x.var(dim=axis, keepdim=True, unbiased=False)
    return (x - m) / torch.sqrt(v + eps)
def _scatter_add(tgt, idx, src, axis=0):
    return tgt.clone().index_add_(axis, idx, src)
def _segment_sum(src, seg, n):
    out = torch.zeros((n,) + src.shape[1:], dtype=src.dtype)
    return out.index_add_(0, seg, src)
def _pad(x, pw):
    flat = tuple(v for pair in reversed(pw) for v in pair)
    return torch.nn.functional.pad(x, flat)

kernel_name = 'interleave_layers__sliding_block_cached__glu_gated_swiglu__decode'

def setup_inputs():

    _w = (lambda a: (lambda t: t.to(torch.bfloat16) if t.is_floating_point() else t)(torch.as_tensor(a)))
    def _A_setup():
        B, Sq, D = 1, 1, 448
        Hq, Hkv, Sk, Dh = 16, 8, 8192, 256
        assert Hq % Hkv == 0, (Hq, Hkv)
        return {
            "x": _w((lambda *s: torch.randn(*s, dtype=torch.bfloat16) * 0.05)(B, Sq, D)),
            "k_cache": _w((lambda *s: torch.randn(*s, dtype=torch.bfloat16) * 1.6)(B, Hkv, Sk, Dh)),
            "v_cache": _w((lambda *s: torch.randn(*s, dtype=torch.bfloat16) * 0.8)(B, Hkv, Sk, Dh)),
            "wq": _w((lambda *s: torch.randn(*s, dtype=torch.bfloat16) * 1.6)(D, Hq * Dh) * (D ** -0.5)),
            "wo": _w((lambda *s: torch.randn(*s, dtype=torch.bfloat16) * 0.8)(Hq * Dh, D) * ((Hq * Dh) ** -0.5)),
        }
    _A_in = _A_setup()

    def _B_setup():
        B, S, D, F = 1, 1, 448, 1792
        return {
            "x": _w((lambda *s: torch.randn(*s, dtype=torch.bfloat16) * 0.05)(B, S, D)),
            "w1": _w((lambda *s: torch.randn(*s, dtype=torch.bfloat16) * 0.4)(D, F) * (2.0 / D) ** 0.5),
            "w3": _w((lambda *s: torch.randn(*s, dtype=torch.bfloat16) * 0.4)(D, F) * (2.0 / D) ** 0.5),
            "w2": _w((lambda *s: torch.randn(*s, dtype=torch.bfloat16) * 0.4)(F, D) * (2.0 / F) ** 0.5),
        }
    _B_in = _B_setup()

    return {
        "A_x": _A_in["x"],
        "A_k_cache": _A_in["k_cache"],
        "A_v_cache": _A_in["v_cache"],
        "A_wq": _A_in["wq"],
        "A_wo": _A_in["wo"],
        "B_x": _B_in["x"],
        "B_w1": _B_in["w1"],
        "B_w3": _B_in["w3"],
        "B_w2": _B_in["w2"],
    }

def reference(A_x, A_k_cache, A_v_cache, A_wq, A_wo, B_x, B_w1, B_w3, B_w2):
    def _A_ref(x, k_cache, v_cache, wq, wo):
        B, Sq, D = x.shape
        Hq, Dh = 16, 256
        Hkv, Sk = k_cache.shape[1], k_cache.shape[2]
        W = min(4096, max(256, Sk // 4))
        rep = Hq // Hkv
        q = (lambda x, *d: x.permute(*d))((x @ wq).reshape(B, Sq, Hq, Dh), 0, 2, 1, 3)
        k = (lambda x, n, axis: torch.repeat_interleave(x, n, dim=axis))(k_cache[:, :, Sk - W:, :], rep, axis=1)
        v = (lambda x, n, axis: torch.repeat_interleave(x, n, dim=axis))(v_cache[:, :, Sk - W:, :], rep, axis=1)
        scores = torch.einsum("bhqd,bhkd->bhqk", q, k) * (Dh ** -0.5)
        p = _softmax(scores, axis=-1)
        o = torch.einsum("bhqk,bhkd->bhqd", p, v)
        return (lambda x, *d: x.permute(*d))(o, 0, 2, 1, 3).reshape(B, Sq, Hq * Dh) @ wo

    def _B_ref(x, w1, w3, w2):
        gate = torch.einsum("bsd,df->bsf", x, w1)
        up = torch.einsum("bsd,df->bsf", x, w3)
        h = _silu(gate) * up
        out = torch.einsum("bsf,fd->bsd", h, w2)
        return out

    x = A_x
    x = x + _A_ref(_layernorm(x, axis=-1), A_k_cache, A_v_cache, A_wq, A_wo)
    x = x + _B_ref(_layernorm(x, axis=-1), B_w1, B_w3, B_w2)
    x = x + _A_ref(_layernorm(x, axis=-1), A_k_cache, A_v_cache, A_wq, A_wo)
    x = x + _B_ref(_layernorm(x, axis=-1), B_w1, B_w3, B_w2)
    return x
```

```asm
; @launch grid=(253,1,1) block=(512,1,1) lds=16384
.amdgcn_target "amdgcn-amd-amdhsa--gfx950"
.text
.globl interleave_layers__sliding_block_cached__glu_gated_swiglu__decode_kernel
.p2align 8
.type interleave_layers__sliding_block_cached__glu_gated_swiglu__decode_kernel,@function
interleave_layers__sliding_block_cached__glu_gated_swiglu__decode_kernel:
    s_cmp_ge_u32 s2, 253
    s_cbranch_scc1 L_end
    s_load_dwordx16 s[64:79], s[0:1], 0
    s_load_dwordx8 s[80:87], s[0:1], 64
    v_lshrrev_b32 v1, 6, v0
    v_and_b32 v0, 63, v0
    s_getreg_b32 s20, hwreg(HW_REG_XCC_ID, 0, 4)
    v_readfirstlane_b32 s22, v1
    s_bfe_u32 s20, s20, 0x10002
    s_lshl_b32 s20, s20, 13
    v_and_b32 v1, 15, v0
    v_lshrrev_b32 v2, 4, v0
    s_cmp_lt_u32 s22, 4
    s_cbranch_scc1 L_np
    s_setprio 3
L_np:
    s_cmp_ge_u32 s2, 225
    s_cbranch_scc1 L_F
    s_cmp_ge_u32 s2, 193
    s_cbranch_scc1 L_W
    s_cmp_eq_u32 s2, 0
    s_cbranch_scc1 L_C
    s_cmp_lt_u32 s2, 65
    s_cbranch_scc1 L_Q
L_A:
    s_sub_u32 s21, s2, 65
    s_lshr_b32 s52, s21, 4
    s_and_b32 s53, s21, 15
    s_cmp_gt_u32 s22, 4
    s_cbranch_scc1 L_exit
    s_cmp_eq_u32 s22, 4
    s_cbranch_scc1 L_Ah
    s_lshl_b32 s27, s52, 22
    s_lshl_b32 s26, s53, 16
    s_add_u32 s27, s27, s26
    s_add_u32 s27, s27, 3145728
    s_lshl_b32 s26, s22, 14
    v_and_b32 v8, 7, v1
    v_lshlrev_b32 v8, 9, v8
    v_lshl_add_u32 v8, v2, 4, v8
    v_lshrrev_b32 v9, 3, v1
    v_lshl_add_u32 v8, v9, 6, v8
    v_add_u32 v16, s26, v8
    v_lshrrev_b32 v8, 1, v2
    v_and_b32 v9, 1, v2
    v_lshl_add_u32 v8, v8, 2, v9
    v_lshlrev_b32 v8, 9, v8
    v_lshl_add_u32 v8, v1, 4, v8
    v_add_u32 v17, s26, v8
    s_mov_b32 s32, 0
    s_mov_b32 s33, 4096
    s_mov_b32 s34, 8192
    s_mov_b32 s35, 12288
    s_waitcnt lgkmcnt(0)
    s_mov_b32 s4, s86
    s_mov_b32 s5, s87
    s_mov_b32 s6, 2097152
    s_mov_b32 s7, 0x20000
    s_add_u32 s8, s66, s27
    s_addc_u32 s9, s67, 0
    s_mov_b32 s10, 65536
    s_mov_b32 s11, 0x20000
    s_add_u32 s12, s68, s27
    s_addc_u32 s13, s69, 0
    s_mov_b32 s14, 65536
    s_mov_b32 s15, 0x20000
    buffer_load_dwordx4 v[128:131], v16, s[8:11], s32 offen offset:0 nt
    buffer_load_dwordx4 v[132:135], v16, s[8:11], s33 offen offset:0 nt
    buffer_load_dwordx4 v[136:139], v16, s[8:11], s32 offen offset:128 nt
    buffer_load_dwordx4 v[140:143], v16, s[8:11], s33 offen offset:128 nt
    buffer_load_dwordx4 v[144:147], v16, s[8:11], s32 offen offset:256 nt
    buffer_load_dwordx4 v[148:151], v16, s[8:11], s33 offen offset:256 nt
    buffer_load_dwordx4 v[152:155], v16, s[8:11], s32 offen offset:384 nt
    buffer_load_dwordx4 v[156:159], v16, s[8:11], s33 offen offset:384 nt
    buffer_load_dwordx4 v[160:163], v16, s[8:11], s34 offen offset:0 nt
    buffer_load_dwordx4 v[164:167], v16, s[8:11], s35 offen offset:0 nt
    buffer_load_dwordx4 v[168:171], v16, s[8:11], s34 offen offset:128 nt
    buffer_load_dwordx4 v[172:175], v16, s[8:11], s35 offen offset:128 nt
    buffer_load_dwordx4 v[176:179], v16, s[8:11], s34 offen offset:256 nt
    buffer_load_dwordx4 v[180:183], v16, s[8:11], s35 offen offset:256 nt
    buffer_load_dwordx4 v[184:187], v16, s[8:11], s34 offen offset:384 nt
    buffer_load_dwordx4 v[188:191], v16, s[8:11], s35 offen offset:384 nt
    s_branch L_A2
L_Q:
    s_sub_u32 s21, s2, 1
    s_cmp_gt_u32 s22, 4
    s_cbranch_scc1 L_exit
    s_cmp_eq_u32 s22, 4
    s_cbranch_scc1 L_Qh
    v_lshrrev_b32 v8, 1, v2
    v_lshrrev_b32 v9, 3, v1
    v_lshl_add_u32 v8, v8, 1, v9
    v_and_b32 v9, 1, v2
    v_lshl_add_u32 v8, v8, 4, v9
    s_lshl_b32 s26, s22, 7
    v_add_u32 v8, s26, v8
    v_mul_u32_u24 v8, 8192, v8
    v_and_b32 v9, 7, v1
    v_lshl_add_u32 v15, v9, 4, v8
    s_lshl_b32 s27, s21, 7
    s_waitcnt lgkmcnt(0)
    s_mov_b32 s4, s86
    s_mov_b32 s5, s87
    s_mov_b32 s6, 2097152
    s_mov_b32 s7, 0x20000
    s_add_u32 s8, s70, s27
    s_addc_u32 s9, s71, 0
    s_mov_b32 s10, 3670016
    s_mov_b32 s11, 0x20000
    s_sub_u32 s10, s10, s27
    s_mov_b32 s26, 0
    buffer_load_dwordx4 v[128:131], v15, s[8:11], s26 offen nt
    s_mov_b32 s26, 524288
    buffer_load_dwordx4 v[132:135], v15, s[8:11], s26 offen nt
    s_mov_b32 s26, 16384
    buffer_load_dwordx4 v[136:139], v15, s[8:11], s26 offen nt
    s_mov_b32 s26, 540672
    buffer_load_dwordx4 v[140:143], v15, s[8:11], s26 offen nt
    s_mov_b32 s26, 32768
    buffer_load_dwordx4 v[144:147], v15, s[8:11], s26 offen nt
    s_mov_b32 s26, 557056
    buffer_load_dwordx4 v[148:151], v15, s[8:11], s26 offen nt
    s_mov_b32 s26, 49152
    buffer_load_dwordx4 v[152:155], v15, s[8:11], s26 offen nt
    s_mov_b32 s26, 573440
    buffer_load_dwordx4 v[156:159], v15, s[8:11], s26 offen nt
    s_mov_b32 s26, 65536
    buffer_load_dwordx4 v[160:163], v15, s[8:11], s26 offen nt
    s_mov_b32 s26, 589824
    buffer_load_dwordx4 v[164:167], v15, s[8:11], s26 offen nt
    s_mov_b32 s26, 81920
    buffer_load_dwordx4 v[168:171], v15, s[8:11], s26 offen nt
    s_mov_b32 s26, 606208
    buffer_load_dwordx4 v[172:175], v15, s[8:11], s26 offen nt
    s_mov_b32 s26, 98304
    buffer_load_dwordx4 v[176:179], v15, s[8:11], s26 offen nt
    s_mov_b32 s26, 622592
    buffer_load_dwordx4 v[180:183], v15, s[8:11], s26 offen nt
    s_mov_b32 s26, 114688
    buffer_load_dwordx4 v[184:187], v15, s[8:11], s26 offen nt
    s_mov_b32 s26, 638976
    buffer_load_dwordx4 v[188:191], v15, s[8:11], s26 offen nt
    s_mov_b32 s16, s64
    s_mov_b32 s17, s65
    s_mov_b32 s18, 896
    s_mov_b32 s19, 0x20000
    v_and_b32 v8, 1, v2
    v_lshlrev_b32 v8, 3, v8
    v_lshl_add_u32 v8, v1, 4, v8
    v_lshrrev_b32 v9, 1, v2
    v_lshl_add_u32 v14, v9, 2, v8
    s_lshl_b32 s26, s22, 8
    buffer_load_dword v25, v14, s[16:19], s26 offen
    s_branch L_Q2
L_A2:
    s_waitcnt vmcnt(15)
    buffer_load_dwordx4 v[192:195], v17, s[12:15], s32 offen offset:0 nt
    s_waitcnt vmcnt(15)
    buffer_load_dwordx4 v[196:199], v17, s[12:15], s33 offen offset:0 nt
    s_waitcnt vmcnt(15)
    buffer_load_dwordx4 v[200:203], v17, s[12:15], s32 offen offset:256 nt
    s_waitcnt vmcnt(15)
    buffer_load_dwordx4 v[204:207], v17, s[12:15], s33 offen offset:256 nt
    s_waitcnt vmcnt(15)
    buffer_load_dwordx4 v[208:211], v17, s[12:15], s32 offen offset:1024 nt
    s_waitcnt vmcnt(15)
    buffer_load_dwordx4 v[212:215], v17, s[12:15], s33 offen offset:1024 nt
    s_waitcnt vmcnt(15)
    buffer_load_dwordx4 v[216:219], v17, s[12:15], s32 offen offset:1280 nt
    s_waitcnt vmcnt(15)
    buffer_load_dwordx4 v[220:223], v17, s[12:15], s33 offen offset:1280 nt
    s_waitcnt vmcnt(15)
    buffer_load_dwordx4 v[224:227], v17, s[12:15], s34 offen offset:0 nt
    s_waitcnt vmcnt(15)
    buffer_load_dwordx4 v[228:231], v17, s[12:15], s35 offen offset:0 nt
    s_waitcnt vmcnt(15)
    buffer_load_dwordx4 v[232:235], v17, s[12:15], s34 offen offset:256 nt
    s_waitcnt vmcnt(15)
    buffer_load_dwordx4 v[236:239], v17, s[12:15], s35 offen offset:256 nt
    s_waitcnt vmcnt(15)
    buffer_load_dwordx4 v[240:243], v17, s[12:15], s34 offen offset:1024 nt
    s_waitcnt vmcnt(15)
    buffer_load_dwordx4 v[244:247], v17, s[12:15], s35 offen offset:1024 nt
    s_waitcnt vmcnt(15)
    buffer_load_dwordx4 v[248:251], v17, s[12:15], s34 offen offset:1280 nt
    s_waitcnt vmcnt(15)
    buffer_load_dwordx4 v[252:255], v17, s[12:15], s35 offen offset:1280 nt
    v_and_b32 v8, 4, v1
    v_cmp_eq_u32 vcc, 0, v8
    v_mov_b32 v9, 0xffff
    s_nop 0
    v_cndmask_b32 v3, 0, v9, vcc
    v_xor_b32 v4, v3, v9
    v_lshlrev_b32 v5, 16, v3
    v_lshlrev_b32 v6, 16, v4
    v_and_b32 v8, 3, v1
    v_mul_u32_u24 v7, 17425, v8
    v_xor_b32 v8, 1, v8
    v_mul_u32_u24 v8, 4420, v8
    v_add_u32 v7, v7, v8
    v_lshrrev_b32 v8, 3, v1
    v_lshlrev_b32 v8, 9, v8
    v_lshl_add_u32 v18, v2, 4, v8
    v_lshrrev_b32 v8, 1, v2
    v_lshlrev_b32 v8, 10, v8
    v_lshl_add_u32 v8, v1, 5, v8
    v_and_b32 v9, 1, v2
    v_lshl_add_u32 v8, v9, 4, v8
    s_lshl_b32 s26, s22, 11
    s_add_u32 s26, s26, 1024
    v_add_u32 v19, s26, v8
    v_lshrrev_b32 v8, 3, v1
    s_lshl_b32 s26, s22, 3
    s_add_u32 s26, s26, 9216
    v_lshl_add_u32 v20, v8, 5, s26
    v_and_b32 v8, 31, v0
    s_lshl_b32 s26, s22, 9
    s_add_u32 s26, s26, 1024
    v_lshl_add_u32 v21, v8, 4, s26
    s_lshr_b32 s26, s22, 1
    s_lshl_b32 s26, s26, 5
    s_add_u32 s26, s26, 9216
    v_mov_b32 v22, s26
    s_lshl_b32 s26, s52, 2
    s_add_u32 s26, s26, s22
    s_lshl_b32 s27, s26, 14
    s_lshl_b32 s30, s53, 9
    s_add_u32 s27, s27, s30
    s_add_u32 s27, s27, 131072
    v_lshrrev_b32 v9, 5, v0
    v_lshlrev_b32 v9, 13, v9
    v_lshl_add_u32 v8, v8, 4, v9
    v_add_u32 v23, s27, v8
    s_lshl_b32 s27, s52, 14
    s_lshl_b32 s30, s22, 11
    s_add_u32 s27, s27, s30
    s_lshl_b32 s30, s53, 7
    s_add_u32 s27, s27, s30
    s_add_u32 s27, s27, 1179648
    v_add_u32 v24, s27, v9
    s_mov_b32 s36, 0x3db8aa3b
    s_mov_b32 s23, 0
    s_waitcnt vmcnt(16)
    v_mov_b32_dpp v60, v128 row_ror:8 row_mask:0xf bank_mask:0xf
    v_mov_b32_dpp v61, v129 row_ror:8 row_mask:0xf bank_mask:0xf
    v_mov_b32_dpp v62, v130 row_ror:8 row_mask:0xf bank_mask:0xf
    v_mov_b32_dpp v63, v131 row_ror:8 row_mask:0xf bank_mask:0xf
    v_mov_b32_dpp v128, v132 row_ror:8 row_mask:0xf bank_mask:0xc
    v_mov_b32_dpp v129, v133 row_ror:8 row_mask:0xf bank_mask:0xc
    v_mov_b32_dpp v130, v134 row_ror:8 row_mask:0xf bank_mask:0xc
    v_mov_b32_dpp v131, v135 row_ror:8 row_mask:0xf bank_mask:0xc
    v_mov_b32_dpp v132, v60 quad_perm:[0,1,2,3] row_mask:0xf bank_mask:0x3
    v_mov_b32_dpp v133, v61 quad_perm:[0,1,2,3] row_mask:0xf bank_mask:0x3
    v_mov_b32_dpp v134, v62 quad_perm:[0,1,2,3] row_mask:0xf bank_mask:0x3
    v_mov_b32_dpp v135, v63 quad_perm:[0,1,2,3] row_mask:0xf bank_mask:0x3
    v_mov_b32_dpp v60, v136 row_ror:8 row_mask:0xf bank_mask:0xf
    v_mov_b32_dpp v61, v137 row_ror:8 row_mask:0xf bank_mask:0xf
    v_mov_b32_dpp v62, v138 row_ror:8 row_mask:0xf bank_mask:0xf
    v_mov_b32_dpp v63, v139 row_ror:8 row_mask:0xf bank_mask:0xf
    v_mov_b32_dpp v136, v140 row_ror:8 row_mask:0xf bank_mask:0xc
    v_mov_b32_dpp v137, v141 row_ror:8 row_mask:0xf bank_mask:0xc
    v_mov_b32_dpp v138, v142 row_ror:8 row_mask:0xf bank_mask:0xc
    v_mov_b32_dpp v139, v143 row_ror:8 row_mask:0xf bank_mask:0xc
    v_mov_b32_dpp v140, v60 quad_perm:[0,1,2,3] row_mask:0xf bank_mask:0x3
    v_mov_b32_dpp v141, v61 quad_perm:[0,1,2,3] row_mask:0xf bank_mask:0x3
    v_mov_b32_dpp v142, v62 quad_perm:[0,1,2,3] row_mask:0xf bank_mask:0x3
    v_mov_b32_dpp v143, v63 quad_perm:[0,1,2,3] row_mask:0xf bank_mask:0x3
    v_mov_b32_dpp v60, v144 row_ror:8 row_mask:0xf bank_mask:0xf
    v_mov_b32_dpp v61, v145 row_ror:8 row_mask:0xf bank_mask:0xf
    v_mov_b32_dpp v62, v146 row_ror:8 row_mask:0xf bank_mask:0xf
    v_mov_b32_dpp v63, v147 row_ror:8 row_mask:0xf bank_mask:0xf
    v_mov_b32_dpp v144, v148 row_ror:8 row_mask:0xf bank_mask:0xc
    v_mov_b32_dpp v145, v149 row_ror:8 row_mask:0xf bank_mask:0xc
    v_mov_b32_dpp v146, v150 row_ror:8 row_mask:0xf bank_mask:0xc
    v_mov_b32_dpp v147, v151 row_ror:8 row_mask:0xf bank_mask:0xc
    v_mov_b32_dpp v148, v60 quad_perm:[0,1,2,3] row_mask:0xf bank_mask:0x3
    v_mov_b32_dpp v149, v61 quad_perm:[0,1,2,3] row_mask:0xf bank_mask:0x3
    v_mov_b32_dpp v150, v62 quad_perm:[0,1,2,3] row_mask:0xf bank_mask:0x3
    v_mov_b32_dpp v151, v63 quad_perm:[0,1,2,3] row_mask:0xf bank_mask:0x3
    v_mov_b32_dpp v60, v152 row_ror:8 row_mask:0xf bank_mask:0xf
    v_mov_b32_dpp v61, v153 row_ror:8 row_mask:0xf bank_mask:0xf
    v_mov_b32_dpp v62, v154 row_ror:8 row_mask:0xf bank_mask:0xf
    v_mov_b32_dpp v63, v155 row_ror:8 row_mask:0xf bank_mask:0xf
    v_mov_b32_dpp v152, v156 row_ror:8 row_mask:0xf bank_mask:0xc
    v_mov_b32_dpp v153, v157 row_ror:8 row_mask:0xf bank_mask:0xc
    v_mov_b32_dpp v154, v158 row_ror:8 row_mask:0xf bank_mask:0xc
    v_mov_b32_dpp v155, v159 row_ror:8 row_mask:0xf bank_mask:0xc
    v_mov_b32_dpp v156, v60 quad_perm:[0,1,2,3] row_mask:0xf bank_mask:0x3
    v_mov_b32_dpp v157, v61 quad_perm:[0,1,2,3] row_mask:0xf bank_mask:0x3
    v_mov_b32_dpp v158, v62 quad_perm:[0,1,2,3] row_mask:0xf bank_mask:0x3
    v_mov_b32_dpp v159, v63 quad_perm:[0,1,2,3] row_mask:0xf bank_mask:0x3
    v_mov_b32_dpp v60, v160 row_ror:8 row_mask:0xf bank_mask:0xf
    v_mov_b32_dpp v61, v161 row_ror:8 row_mask:0xf bank_mask:0xf
    v_mov_b32_dpp v62, v162 row_ror:8 row_mask:0xf bank_mask:0xf
    v_mov_b32_dpp v63, v163 row_ror:8 row_mask:0xf bank_mask:0xf
    v_mov_b32_dpp v160, v164 row_ror:8 row_mask:0xf bank_mask:0xc
    v_mov_b32_dpp v161, v165 row_ror:8 row_mask:0xf bank_mask:0xc
    v_mov_b32_dpp v162, v166 row_ror:8 row_mask:0xf bank_mask:0xc
    v_mov_b32_dpp v163, v167 row_ror:8 row_mask:0xf bank_mask:0xc
    v_mov_b32_dpp v164, v60 quad_perm:[0,1,2,3] row_mask:0xf bank_mask:0x3
    v_mov_b32_dpp v165, v61 quad_perm:[0,1,2,3] row_mask:0xf bank_mask:0x3
    v_mov_b32_dpp v166, v62 quad_perm:[0,1,2,3] row_mask:0xf bank_mask:0x3
    v_mov_b32_dpp v167, v63 quad_perm:[0,1,2,3] row_mask:0xf bank_mask:0x3
    v_mov_b32_dpp v60, v168 row_ror:8 row_mask:0xf bank_mask:0xf
    v_mov_b32_dpp v61, v169 row_ror:8 row_mask:0xf bank_mask:0xf
    v_mov_b32_dpp v62, v170 row_ror:8 row_mask:0xf bank_mask:0xf
    v_mov_b32_dpp v63, v171 row_ror:8 row_mask:0xf bank_mask:0xf
    v_mov_b32_dpp v168, v172 row_ror:8 row_mask:0xf bank_mask:0xc
    v_mov_b32_dpp v169, v173 row_ror:8 row_mask:0xf bank_mask:0xc
    v_mov_b32_dpp v170, v174 row_ror:8 row_mask:0xf bank_mask:0xc
    v_mov_b32_dpp v171, v175 row_ror:8 row_mask:0xf bank_mask:0xc
    v_mov_b32_dpp v172, v60 quad_perm:[0,1,2,3] row_mask:0xf bank_mask:0x3
    v_mov_b32_dpp v173, v61 quad_perm:[0,1,2,3] row_mask:0xf bank_mask:0x3
    v_mov_b32_dpp v174, v62 quad_perm:[0,1,2,3] row_mask:0xf bank_mask:0x3
    v_mov_b32_dpp v175, v63 quad_perm:[0,1,2,3] row_mask:0xf bank_mask:0x3
    v_mov_b32_dpp v60, v176 row_ror:8 row_mask:0xf bank_mask:0xf
    v_mov_b32_dpp v61, v177 row_ror:8 row_mask:0xf bank_mask:0xf
    v_mov_b32_dpp v62, v178 row_ror:8 row_mask:0xf bank_mask:0xf
    v_mov_b32_dpp v63, v179 row_ror:8 row_mask:0xf bank_mask:0xf
    v_mov_b32_dpp v176, v180 row_ror:8 row_mask:0xf bank_mask:0xc
    v_mov_b32_dpp v177, v181 row_ror:8 row_mask:0xf bank_mask:0xc
    v_mov_b32_dpp v178, v182 row_ror:8 row_mask:0xf bank_mask:0xc
    v_mov_b32_dpp v179, v183 row_ror:8 row_mask:0xf bank_mask:0xc
    v_mov_b32_dpp v180, v60 quad_perm:[0,1,2,3] row_mask:0xf bank_mask:0x3
    v_mov_b32_dpp v181, v61 quad_perm:[0,1,2,3] row_mask:0xf bank_mask:0x3
    v_mov_b32_dpp v182, v62 quad_perm:[0,1,2,3] row_mask:0xf bank_mask:0x3
    v_mov_b32_dpp v183, v63 quad_perm:[0,1,2,3] row_mask:0xf bank_mask:0x3
    v_mov_b32_dpp v60, v184 row_ror:8 row_mask:0xf bank_mask:0xf
    v_mov_b32_dpp v61, v185 row_ror:8 row_mask:0xf bank_mask:0xf
    v_mov_b32_dpp v62, v186 row_ror:8 row_mask:0xf bank_mask:0xf
    v_mov_b32_dpp v63, v187 row_ror:8 row_mask:0xf bank_mask:0xf
    v_mov_b32_dpp v184, v188 row_ror:8 row_mask:0xf bank_mask:0xc
    v_mov_b32_dpp v185, v189 row_ror:8 row_mask:0xf bank_mask:0xc
    v_mov_b32_dpp v186, v190 row_ror:8 row_mask:0xf bank_mask:0xc
    v_mov_b32_dpp v187, v191 row_ror:8 row_mask:0xf bank_mask:0xc
    v_mov_b32_dpp v188, v60 quad_perm:[0,1,2,3] row_mask:0xf bank_mask:0x3
    v_mov_b32_dpp v189, v61 quad_perm:[0,1,2,3] row_mask:0xf bank_mask:0x3
    v_mov_b32_dpp v190, v62 quad_perm:[0,1,2,3] row_mask:0xf bank_mask:0x3
    v_mov_b32_dpp v191, v63 quad_perm:[0,1,2,3] row_mask:0xf bank_mask:0x3
L_Al:
    s_barrier
    ds_read_b128 v[60:63], v18 offset:0
    ds_read_b128 v[64:67], v18 offset:64
    ds_read_b128 v[68:71], v18 offset:128
    ds_read_b128 v[72:75], v18 offset:192
    ds_read_b128 v[76:79], v18 offset:256
    ds_read_b128 v[80:83], v18 offset:320
    ds_read_b128 v[84:87], v18 offset:384
    ds_read_b128 v[88:91], v18 offset:448
    s_waitcnt lgkmcnt(7)
    v_mfma_f32_16x16x32_bf16 v[44:47], v[128:131], v[60:63], 0
    v_mfma_f32_16x16x32_bf16 v[48:51], v[160:163], v[60:63], 0
    s_waitcnt lgkmcnt(6)
    v_mfma_f32_16x16x32_bf16 v[44:47], v[132:135], v[64:67], v[44:47]
    v_mfma_f32_16x16x32_bf16 v[48:51], v[164:167], v[64:67], v[48:51]
    s_waitcnt lgkmcnt(5)
    v_mfma_f32_16x16x32_bf16 v[44:47], v[136:139], v[68:71], v[44:47]
    v_mfma_f32_16x16x32_bf16 v[48:51], v[168:171], v[68:71], v[48:51]
    s_waitcnt lgkmcnt(4)
    v_mfma_f32_16x16x32_bf16 v[44:47], v[140:143], v[72:75], v[44:47]
    v_mfma_f32_16x16x32_bf16 v[48:51], v[172:175], v[72:75], v[48:51]
    s_waitcnt lgkmcnt(3)
    v_mfma_f32_16x16x32_bf16 v[44:47], v[144:147], v[76:79], v[44:47]
    v_mfma_f32_16x16x32_bf16 v[48:51], v[176:179], v[76:79], v[48:51]
    s_waitcnt lgkmcnt(2)
    v_mfma_f32_16x16x32_bf16 v[44:47], v[148:151], v[80:83], v[44:47]
    v_mfma_f32_16x16x32_bf16 v[48:51], v[180:183], v[80:83], v[48:51]
    s_waitcnt lgkmcnt(1)
    v_mfma_f32_16x16x32_bf16 v[44:47], v[152:155], v[84:87], v[44:47]
    v_mfma_f32_16x16x32_bf16 v[48:51], v[184:187], v[84:87], v[48:51]
    s_waitcnt lgkmcnt(0)
    v_mfma_f32_16x16x32_bf16 v[44:47], v[156:159], v[88:91], v[44:47]
    v_mfma_f32_16x16x32_bf16 v[48:51], v[188:191], v[88:91], v[48:51]
    v_mov_b32 v92, 0
    v_mov_b32 v93, 0
    v_mov_b32 v94, 0
    v_mov_b32 v95, 0
    v_mov_b32 v96, 0
    v_mov_b32 v97, 0
    v_mov_b32 v98, 0
    v_mov_b32 v99, 0
    v_cvt_pk_bf16_f32 v52, v44, v45
    v_cvt_pk_bf16_f32 v53, v46, v47
    v_cvt_pk_bf16_f32 v54, v48, v49
    v_cvt_pk_bf16_f32 v55, v50, v51
    v_lshlrev_b32 v44, 16, v52
    v_and_b32 v45, 0xffff0000, v52
    v_lshlrev_b32 v46, 16, v53
    v_and_b32 v47, 0xffff0000, v53
    v_lshlrev_b32 v48, 16, v54
    v_and_b32 v49, 0xffff0000, v54
    v_lshlrev_b32 v50, 16, v55
    v_and_b32 v51, 0xffff0000, v55
    v_max3_f32 v52, v44, v45, v46
    v_max3_f32 v53, v47, v48, v49
    v_max3_f32 v52, v50, v51, v52
    v_max_f32 v52, v52, v53
    v_mov_b32 v53, v52
    s_nop 1
    v_permlane32_swap_b32 v52, v53
    v_max_f32 v52, v52, v53
    v_mov_b32 v53, v52
    s_nop 1
    v_permlane16_swap_b32 v52, v53
    v_max_f32 v52, v52, v53
    v_mul_f32 v56, s36, v52
    v_fma_f32 v44, v44, s36, -v56
    v_fma_f32 v45, v45, s36, -v56
    v_fma_f32 v46, v46, s36, -v56
    v_fma_f32 v47, v47, s36, -v56
    v_fma_f32 v48, v48, s36, -v56
    v_fma_f32 v49, v49, s36, -v56
    v_fma_f32 v50, v50, s36, -v56
    v_fma_f32 v51, v51, s36, -v56
    v_exp_f32 v44, v44
    v_exp_f32 v45, v45
    v_exp_f32 v46, v46
    v_exp_f32 v47, v47
    v_exp_f32 v48, v48
    v_exp_f32 v49, v49
    v_exp_f32 v50, v50
    v_exp_f32 v51, v51
    v_cvt_pk_bf16_f32 v52, v44, v45
    v_cvt_pk_bf16_f32 v53, v46, v47
    v_cvt_pk_bf16_f32 v54, v48, v49
    v_cvt_pk_bf16_f32 v55, v50, v51
    v_and_b32 v34, v52, v3
    v_and_b32 v35, v52, v4
    v_and_b32 v36, v52, v5
    v_and_b32 v37, v52, v6
    s_waitcnt vmcnt(0)
    v_and_b32 v38, v53, v3
    v_and_b32 v39, v53, v4
    v_and_b32 v40, v53, v5
    v_and_b32 v41, v53, v6
    v_smfmac_f32_16x16x64_bf16 v[92:95], v[34:37], v[192:199], v7
    v_smfmac_f32_16x16x64_bf16 v[96:99], v[34:37], v[200:207], v7
    v_pk_add_f32 v[44:45], v[44:45], v[46:47]
    v_pk_add_f32 v[48:49], v[48:49], v[50:51]
    v_and_b32 v34, v54, v3
    v_and_b32 v35, v54, v4
    v_and_b32 v36, v54, v5
    v_and_b32 v37, v54, v6
    v_smfmac_f32_16x16x64_bf16 v[92:95], v[38:41], v[208:215], v7
    v_smfmac_f32_16x16x64_bf16 v[96:99], v[38:41], v[216:223], v7
    v_pk_add_f32 v[44:45], v[44:45], v[48:49]
    v_add_f32 v57, v44, v45
    v_mov_b32 v58, v57
    v_and_b32 v38, v55, v3
    v_and_b32 v39, v55, v4
    v_and_b32 v40, v55, v5
    v_and_b32 v41, v55, v6
    v_smfmac_f32_16x16x64_bf16 v[92:95], v[34:37], v[224:231], v7
    v_smfmac_f32_16x16x64_bf16 v[96:99], v[34:37], v[232:239], v7
    v_permlane32_swap_b32 v57, v58
    v_add_f32 v57, v57, v58
    v_mov_b32 v58, v57
    v_smfmac_f32_16x16x64_bf16 v[92:95], v[38:41], v[240:247], v7
    v_smfmac_f32_16x16x64_bf16 v[96:99], v[38:41], v[248:255], v7
    v_permlane16_swap_b32 v57, v58
    v_add_f32 v57, v57, v58
    s_mul_i32 s26, s23, 524288
    s_lshl_b32 s27, s23, 17
    s_mov_b64 exec, 0x101
    ds_write_b64 v20, v[56:57]
    s_mov_b64 exec, -1
    ds_write_b128 v19, v[92:95]
    ds_write_b128 v19, v[96:99] offset:512
    s_waitcnt lgkmcnt(0)
    s_barrier
    ds_read_b128 v[44:47], v22
    ds_read_b128 v[48:51], v22 offset:16
    ds_read_b128 v[60:63], v21
    ds_read_b128 v[64:67], v21 offset:2048
    ds_read_b128 v[68:71], v21 offset:4096
    ds_read_b128 v[72:75], v21 offset:6144
    s_waitcnt lgkmcnt(4)
    v_max3_f32 v56, v44, v46, v48
    v_max_f32 v56, v56, v50
    v_sub_f32 v52, v44, v56
    v_sub_f32 v53, v46, v56
    v_sub_f32 v54, v48, v56
    v_sub_f32 v55, v50, v56
    v_exp_f32 v52, v52
    v_exp_f32 v53, v53
    v_exp_f32 v54, v54
    v_exp_f32 v55, v55
    v_mul_f32 v57, v52, v45
    v_fmac_f32 v57, v53, v47
    v_fmac_f32 v57, v54, v49
    v_fmac_f32 v57, v55, v51
    v_min_u32 v56, -2, v56
    s_waitcnt lgkmcnt(3)
    v_pk_mul_f32 v[60:61], v[60:61], v[52:53] op_sel_hi:[1,0]
    v_pk_mul_f32 v[62:63], v[62:63], v[52:53] op_sel_hi:[1,0]
    s_mov_b32 exec_lo, 1
    s_mov_b32 exec_hi, 1
    buffer_store_dwordx2 v[56:57], v24, s[4:7], s27 offen sc1
    s_mov_b64 exec, -1
    s_waitcnt lgkmcnt(2)
    v_pk_fma_f32 v[60:61], v[64:65], v[52:53], v[60:61] op_sel:[0,1,0] op_sel_hi:[1,1,1]
    v_pk_fma_f32 v[62:63], v[66:67], v[52:53], v[62:63] op_sel:[0,1,0] op_sel_hi:[1,1,1]
    s_waitcnt lgkmcnt(1)
    v_pk_fma_f32 v[60:61], v[68:69], v[54:55], v[60:61] op_sel_hi:[1,0,1]
    v_pk_fma_f32 v[62:63], v[70:71], v[54:55], v[62:63] op_sel_hi:[1,0,1]
    s_waitcnt lgkmcnt(0)
    v_pk_fma_f32 v[60:61], v[72:73], v[54:55], v[60:61] op_sel:[0,1,0] op_sel_hi:[1,1,1]
    v_pk_fma_f32 v[62:63], v[74:75], v[54:55], v[62:63] op_sel:[0,1,0] op_sel_hi:[1,1,1]
    v_min_u32 v60, -2, v60
    buffer_store_dwordx4 v[60:63], v23, s[4:7], s26 offen sc1
    s_add_u32 s23, s23, 1
    s_cmp_lt_i32 s23, 2
    s_cbranch_scc1 L_Al
    s_branch L_exit
L_Ah:
    s_waitcnt lgkmcnt(0)
    s_mov_b32 s4, s86
    s_mov_b32 s5, s87
    s_mov_b32 s6, 2097152
    s_mov_b32 s7, 0x20000
    v_mov_b32 v8, 0
    buffer_load_dword v9, v8, s[4:7], 0 offen sc1
    v_mov_b32 v12, -1
    v_mov_b32 v13, -1
    v_mov_b32 v14, -1
    v_mov_b32 v15, -1
    v_and_b32 v8, 31, v0
    v_lshrrev_b32 v11, 5, v0
    v_lshlrev_b32 v11, 13, v11
    v_lshl_add_u32 v10, v8, 4, v11
    s_lshl_b32 s27, s52, 16
    s_lshl_b32 s30, s53, 9
    s_add_u32 s27, s27, s30
    s_add_u32 s27, s27, 131072
    s_add_u32 s26, s27, 0
    buffer_store_dwordx4 v[12:15], v10, s[4:7], s26 offen sc1
    s_add_u32 s26, s27, 16384
    buffer_store_dwordx4 v[12:15], v10, s[4:7], s26 offen sc1
    s_add_u32 s26, s27, 32768
    buffer_store_dwordx4 v[12:15], v10, s[4:7], s26 offen sc1
    s_add_u32 s26, s27, 49152
    buffer_store_dwordx4 v[12:15], v10, s[4:7], s26 offen sc1
    s_add_u32 s26, s27, 524288
    buffer_store_dwordx4 v[12:15], v10, s[4:7], s26 offen sc1
    s_add_u32 s26, s27, 540672
    buffer_store_dwordx4 v[12:15], v10, s[4:7], s26 offen sc1
    s_add_u32 s26, s27, 557056
    buffer_store_dwordx4 v[12:15], v10, s[4:7], s26 offen sc1
    s_add_u32 s26, s27, 573440
    buffer_store_dwordx4 v[12:15], v10, s[4:7], s26 offen sc1
    v_and_b32 v8, 3, v0
    v_lshlrev_b32 v8, 11, v8
    v_bfe_u32 v11, v0, 2, 1
    v_lshl_add_u32 v8, v11, 13, v8
    v_bfe_u32 v11, v0, 3, 1
    v_lshl_add_u32 v8, v11, 17, v8
    s_lshl_b32 s27, s52, 14
    s_lshl_b32 s30, s53, 7
    s_add_u32 s27, s27, s30
    s_add_u32 s27, s27, 1179648
    s_mov_b64 exec, 0xffff
    buffer_store_dwordx4 v[12:15], v8, s[4:7], s27 offen sc1
    s_mov_b64 exec, -1
    v_lshlrev_b32 v16, 3, v0
    s_lshr_b32 s26, s52, 2
    s_lshl_b32 s26, s26, 14
    s_and_b32 s27, s52, 3
    s_lshl_b32 s27, s27, 11
    s_add_u32 s26, s26, s27
    s_add_u32 s30, s26, 49152
    v_lshlrev_b32 v17, 4, v0
    s_mov_b32 s23, 0
    s_add_u32 s31, s30, s20
    s_mov_b32 s25, 0
    buffer_load_dwordx4 v[20:23], v17, s[4:7], s31 offen sc1
    buffer_load_dwordx4 v[24:27], v17, s[4:7], s31 offen offset:1024 sc1
    s_waitcnt vmcnt(2)
    v_readfirstlane_b32 s24, v9
    s_nop 0
    s_mul_i32 s24, s24, 0x9E3779B1
    s_add_u32 s24, s24, 0x7F4A7C15
    s_lshr_b32 s26, s2, 7
    s_lshl_b32 s26, s26, 14
    s_and_b32 s27, s2, 127
    s_lshl_b32 s27, s27, 6
    s_add_u32 s26, s26, s27
    s_add_u32 s26, s26, 16384
    v_mov_b32 v8, 0
    v_mov_b32 v11, s24
    s_mov_b64 exec, 1
    buffer_store_dword v11, v8, s[4:7], s26 offen sc1
    s_mov_b64 exec, -1
    s_branch L_Ahp0
L_Ahl:
    s_lshl_b32 s31, s23, 15
    s_add_u32 s31, s31, s30
    s_add_u32 s31, s31, s20
    s_mov_b32 s25, 0
    buffer_load_dwordx4 v[20:23], v17, s[4:7], s31 offen sc1
    buffer_load_dwordx4 v[24:27], v17, s[4:7], s31 offen offset:1024 sc1
L_Ahp0:
L_Ahp:
    buffer_load_dwordx4 v[28:31], v17, s[4:7], s31 offen sc1
    buffer_load_dwordx4 v[32:35], v17, s[4:7], s31 offen offset:1024 sc1
    s_add_u32 s25, s25, 1
    s_cmp_gt_u32 s25, 20000
    s_cbranch_scc1 L_exit
    s_waitcnt vmcnt(2)
    v_xor_b32 v18, s24, v21
    v_xor_b32 v19, s24, v23
    v_xor_b32 v21, s24, v25
    v_xor_b32 v23, s24, v27
    v_or3_b32 v18, v18, v19, v21
    v_or_b32 v18, v18, v23
    v_cmp_ne_u32 vcc, 0, v18
    s_nop 0
    s_cbranch_vccz L_Ahd0
    buffer_load_dwordx4 v[20:23], v17, s[4:7], s31 offen sc1
    buffer_load_dwordx4 v[24:27], v17, s[4:7], s31 offen offset:1024 sc1
    s_waitcnt vmcnt(2)
    v_xor_b32 v18, s24, v29
    v_xor_b32 v19, s24, v31
    v_xor_b32 v29, s24, v33
    v_xor_b32 v31, s24, v35
    v_or3_b32 v18, v18, v19, v29
    v_or_b32 v18, v18, v31
    v_cmp_ne_u32 vcc, 0, v18
    s_nop 0
    s_cbranch_vccnz L_Ahp
L_Ahd1:
    ds_write2_b32 v16, v28, v30 offset0:0 offset1:1
    ds_write2_b32 v16, v32, v34 offset0:128 offset1:129
    s_branch L_Ahe
L_Ahd0:
    ds_write2_b32 v16, v20, v22 offset0:0 offset1:1
    ds_write2_b32 v16, v24, v26 offset0:128 offset1:129
L_Ahe:
    s_waitcnt lgkmcnt(0)
    s_barrier
    s_waitcnt vmcnt(0)
    s_barrier
    s_cmp_eq_u32 s23, 1
    s_cbranch_scc1 L_exit
    s_mov_b32 s23, 1
    s_mov_b32 s27, 0
    v_add_u32 v8, s27, v0
    v_cmp_ne_u32 vcc, 0, v0
    s_nop 1
    v_cndmask_b32 v8, 0, v8, vcc
    v_cndmask_b32_e64 v9, 1, 0, vcc
    v_lshrrev_b32 v11, 7, v8
    v_lshlrev_b32 v11, 14, v11
    v_and_b32 v8, 127, v8
    v_lshl_add_u32 v8, v8, 6, v11
    s_mov_b32 s26, 16384
    s_mov_b32 s25, 0
    s_mov_b32 exec_lo, 0x1
    s_mov_b32 exec_hi, 0x0
L_fp_a:
    buffer_load_dword v11, v8, s[4:7], s26 offen sc1
    s_add_u32 s25, s25, 1
    s_cmp_gt_u32 s25, 20000
    s_cbranch_scc1 L_exit
    s_waitcnt vmcnt(0)
    v_xor_b32 v11, s24, v11
    v_cmp_gt_u32 vcc, v11, v9
    s_nop 0
    s_cbranch_vccnz L_fp_a
    v_readlane_b32 s26, v11, 0
    s_mov_b64 exec, -1
    s_lshl_b32 s26, s26, 13
    s_xor_b32 s20, s20, s26
    s_branch L_Ahl
L_Q2:
    v_and_b32 v8, 4, v1
    v_cmp_eq_u32 vcc, 0, v8
    v_mov_b32 v9, 0xffff
    s_nop 0
    v_cndmask_b32 v3, 0, v9, vcc
    v_xor_b32 v4, v3, v9
    v_lshlrev_b32 v5, 16, v3
    v_lshlrev_b32 v6, 16, v4
    v_and_b32 v8, 3, v1
    v_mul_u32_u24 v7, 17425, v8
    v_xor_b32 v8, 1, v8
    v_mul_u32_u24 v8, 4420, v8
    v_add_u32 v7, v7, v8
    s_mov_b32 s50, 0x00ff00ff
    s_mov_b32 s51, 0xff00ff00
    s_mov_b32 s48, 0
    s_mov_b32 s49, -1
    s_cmp_eq_u32 s22, 3
    s_cselect_b32 s28, 0x00ff00ff, -1
    s_mov_b32 s29, s28
    s_lshl_b32 s26, s22, 8
    v_lshlrev_b32 v8, 10, v2
    v_lshl_add_u32 v8, v1, 4, v8
    v_add_u32 v16, s26, v8
    v_add_u32 v18, s26, v14
    s_add_u32 s27, s26, 1720320
    v_add_u32 v17, s27, v14
    v_lshrrev_b32 v11, 3, v0
    v_lshl_add_u32 v19, v11, 5, s26
    v_lshlrev_b32 v8, 14, v11
    v_and_b32 v9, 7, v0
    v_lshl_add_u32 v8, v9, 10, v8
    s_add_u32 s27, s26, 1589248
    v_add_u32 v13, s27, v8
    v_lshrrev_b32 v11, 3, v1
    v_lshlrev_b32 v11, 8, v11
    v_and_b32 v12, 7, v1
    v_lshl_add_u32 v11, v12, 5, v11
    v_and_b32 v12, 1, v2
    v_lshl_add_u32 v11, v12, 4, v11
    s_lshl_b32 s26, s22, 9
    s_add_u32 s26, s26, 1024
    v_add_u32 v20, s26, v11
    s_lshl_b32 s26, s22, 3
    s_add_u32 s26, s26, 5120
    v_lshrrev_b32 v8, 5, v0
    v_lshl_add_u32 v21, v8, 2, s26
    v_and_b32 v92, 0x3f803f80, v3
    v_and_b32 v93, 0x3f803f80, v4
    v_and_b32 v94, 0x3f803f80, v5
    v_and_b32 v95, 0x3f803f80, v6
    v_mov_b32 v22, 0
    v_mov_b32 v60, 0
    v_mov_b32 v61, 0
    v_mov_b32 v62, 0
    v_mov_b32 v63, 0
    v_mov_b32 v64, 0
    v_mov_b32 v65, 0
    v_mov_b32 v66, 0
    v_mov_b32 v67, 0
    v_mov_b32 v68, 0
    v_mov_b32 v69, 0
    v_mov_b32 v70, 0
    v_mov_b32 v71, 0
    v_mov_b32 v72, 0
    v_mov_b32 v73, 0
    v_mov_b32 v74, 0
    v_mov_b32 v75, 0
    v_mov_b32 v76, 0
    v_mov_b32 v77, 0
    v_mov_b32 v78, 0
    v_mov_b32 v79, 0
    v_mov_b32 v80, 0
    v_mov_b32 v81, 0
    v_mov_b32 v82, 0
    v_mov_b32 v83, 0
    v_mov_b32 v84, 0
    v_mov_b32 v85, 0
    v_mov_b32 v86, 0
    v_mov_b32 v87, 0
    v_mov_b32 v88, 0
    v_mov_b32 v89, 0
    v_mov_b32 v90, 0
    v_mov_b32 v91, 0
    s_mov_b32 s32, 1589248
    s_mov_b32 s33, 1593344
    s_mov_b32 s34, 1605632
    s_mov_b32 s35, 1609728
    s_mov_b32 s36, 1622016
    s_mov_b32 s37, 1626112
    s_mov_b32 s38, 1638400
    s_mov_b32 s39, 1642496
    v_lshlrev_b32 v58, 2, v0
    v_add_u32 v58, 1024, v58
    s_lshr_b32 s26, s21, 5
    s_lshl_b32 s26, s26, 14
    s_and_b32 s27, s21, 31
    s_lshl_b32 s27, s27, 8
    s_add_u32 s26, s26, s27
    s_add_u32 s26, s26, 49152
    v_lshl_add_u32 v59, v0, 2, s26
    v_mov_b32 v99, 12288
    s_mov_b32 s23, 0
    s_branch L_Qg0
L_Qloop:
    v_mov_b32 v8, 12288
    ds_read_b32 v9, v8
    s_waitcnt lgkmcnt(0)
    v_readfirstlane_b32 s24, v9
    s_mov_b32 s27, 225
    v_add_u32 v8, s27, v0
    v_cmp_ne_u32 vcc, 28, v0
    s_nop 1
    v_cndmask_b32 v8, 0, v8, vcc
    v_cndmask_b32_e64 v9, 1, 0, vcc
    v_lshrrev_b32 v11, 7, v8
    v_lshlrev_b32 v11, 14, v11
    v_and_b32 v8, 127, v8
    v_lshl_add_u32 v8, v8, 6, v11
    s_mov_b32 s26, 16384
    s_mov_b32 s25, 0
    s_mov_b32 exec_lo, 0x1fffffff
    s_mov_b32 exec_hi, 0x0
L_fp_q:
    buffer_load_dword v11, v8, s[4:7], s26 offen sc1
    s_add_u32 s25, s25, 1
    s_cmp_gt_u32 s25, 20000
    s_cbranch_scc1 L_exit
    s_waitcnt vmcnt(0)
    v_xor_b32 v11, s24, v11
    v_cmp_gt_u32 vcc, v11, v9
    s_nop 0
    s_cbranch_vccnz L_fp_q
    v_readlane_b32 s26, v11, 28
    s_mov_b64 exec, -1
    s_lshl_b32 s26, s26, 13
    s_xor_b32 s20, s20, s26
    v_add_u32 v16, s20, v16
    v_add_u32 v17, s20, v17
    v_add_u32 v13, s20, v13
    s_mov_b32 s25, 0
    s_mov_b32 exec_lo, 0xfffffff
    s_mov_b32 exec_hi, 0
L_gl_q:
    buffer_load_dword v54, v13, s[4:7], 0 offen sc1
    s_add_u32 s25, s25, 1
    s_cmp_gt_u32 s25, 20000
    s_cbranch_scc1 L_exit
    s_waitcnt vmcnt(0)
    v_cmp_ne_u32 vcc, -1, v54
    s_nop 0
    s_cbranch_vccz L_gl_q
L_gp_q:
    s_mov_b64 exec, s[28:29]
    buffer_load_dword v22, v17, s[4:7], 0 offen sc1
    buffer_load_dwordx4 v[60:63], v16, s[4:7], s32 offen sc1
    buffer_load_dwordx4 v[64:67], v16, s[4:7], s33 offen sc1
    buffer_load_dwordx4 v[68:71], v16, s[4:7], s34 offen sc1
    buffer_load_dwordx4 v[72:75], v16, s[4:7], s35 offen sc1
    buffer_load_dwordx4 v[76:79], v16, s[4:7], s36 offen sc1
    buffer_load_dwordx4 v[80:83], v16, s[4:7], s37 offen sc1
    buffer_load_dwordx4 v[84:87], v16, s[4:7], s38 offen sc1
L_gc_q:
    s_mov_b64 exec, -1
    s_add_u32 s25, s25, 1
    s_cmp_gt_u32 s25, 20000
    s_cbranch_scc1 L_exit
    v_mov_b32 v42, 0
    v_mov_b32 v43, 0
    v_mov_b32 v44, 0
    v_mov_b32 v45, 0
    s_waitcnt vmcnt(5)
    s_nop 0
    v_smfmac_f32_16x16x64_bf16 v[42:45], v[92:95], v[60:67], v7
    v_max3_u32 v54, v22, v60, v64
    v_lshlrev_b32 v52, 16, v22
    v_and_b32 v53, 0xffff0000, v22
    s_waitcnt vmcnt(3)
    v_smfmac_f32_16x16x64_bf16 v[42:45], v[92:95], v[68:75], v7
    v_max3_u32 v54, v54, v68, v72
    s_waitcnt vmcnt(1)
    v_smfmac_f32_16x16x64_bf16 v[42:45], v[92:95], v[76:83], v7
    v_max3_u32 v54, v54, v76, v80
    s_waitcnt vmcnt(0)
    v_smfmac_f32_16x16x64_bf16 v[42:45], v[92:95], v[84:91], v7
    v_max3_u32 v54, v54, v84, v88
    v_cmp_eq_u32 vcc, -1, v54
    s_nop 0
    s_cbranch_vccnz L_gp_q
    s_nop 3
    v_cndmask_b32 v50, v42, v44, s[48:49]
    v_cndmask_b32 v51, v43, v45, s[48:49]
    v_cvt_pk_bf16_f32 v55, v50, v51
    v_lshlrev_b32 v50, 16, v55
    v_and_b32 v51, 0xffff0000, v55
    v_pk_add_f32 v[50:51], v[50:51], v[52:53]
    v_cvt_pk_bf16_f32 v24, v50, v51
    s_branch L_Qg
L_Qg0:
    s_waitcnt vmcnt(0)
    v_mov_b32 v24, v25
L_Qg:
    ds_write_b32 v18, v24
    v_lshlrev_b32 v50, 16, v24
    v_and_b32 v51, 0xffff0000, v24
    v_mov_b32 v42, 0
    v_mov_b32 v43, 0
    s_waitcnt lgkmcnt(0)
    ds_read_b128 v[26:29], v19
    ds_read_b128 v[30:33], v19 offset:16
    v_add_f32 v55, v50, v51
    v_mul_f32 v56, v50, v50
    v_fmac_f32 v56, v51, v51
    v_mov_b32 v44, 0
    v_mov_b32 v45, 0
    v_permlane32_swap_b32 v55, v56
    v_add_f32 v55, v55, v56
    s_and_b32 s26, s23, 1
    s_mul_i32 s26, s26, 4352
    v_add_u32 v8, s26, v20
    v_add_u32 v9, s26, v21
    s_waitcnt lgkmcnt(1)
    v_and_b32 v34, v26, v3
    v_and_b32 v35, v26, v4
    v_and_b32 v36, v26, v5
    v_and_b32 v37, v26, v6
    v_and_b32 v38, v27, v3
    v_and_b32 v39, v27, v4
    v_and_b32 v40, v27, v5
    v_and_b32 v41, v27, v6
    v_smfmac_f32_16x16x64_bf16 v[42:45], v[34:37], v[128:135], v7
    v_mov_b32 v56, v55
    v_and_b32 v34, v28, v3
    v_and_b32 v35, v28, v4
    v_and_b32 v36, v28, v5
    v_and_b32 v37, v28, v6
    v_smfmac_f32_16x16x64_bf16 v[42:45], v[38:41], v[136:143], v7
    v_and_b32 v38, v29, v3
    v_and_b32 v39, v29, v4
    v_and_b32 v40, v29, v5
    v_and_b32 v41, v29, v6
    v_smfmac_f32_16x16x64_bf16 v[42:45], v[34:37], v[144:151], v7
    v_permlane16_swap_b32 v55, v56
    v_add_f32 v55, v55, v56
    s_waitcnt lgkmcnt(0)
    v_and_b32 v34, v30, v3
    v_and_b32 v35, v30, v4
    v_and_b32 v36, v30, v5
    v_and_b32 v37, v30, v6
    v_smfmac_f32_16x16x64_bf16 v[42:45], v[38:41], v[152:159], v7
    v_add_f32_dpp v55, v55, v55 row_ror:8 row_mask:0xf bank_mask:0xf
    v_and_b32 v38, v31, v3
    v_and_b32 v39, v31, v4
    v_and_b32 v40, v31, v5
    v_and_b32 v41, v31, v6
    v_smfmac_f32_16x16x64_bf16 v[42:45], v[34:37], v[160:167], v7
    v_add_f32_dpp v55, v55, v55 row_ror:4 row_mask:0xf bank_mask:0xf
    v_and_b32 v34, v32, v3
    v_and_b32 v35, v32, v4
    v_and_b32 v36, v32, v5
    v_and_b32 v37, v32, v6
    v_smfmac_f32_16x16x64_bf16 v[42:45], v[38:41], v[168:175], v7
    v_add_f32_dpp v55, v55, v55 row_ror:2 row_mask:0xf bank_mask:0xf
    v_and_b32 v38, v33, v3
    v_and_b32 v39, v33, v4
    v_and_b32 v40, v33, v5
    v_and_b32 v41, v33, v6
    v_smfmac_f32_16x16x64_bf16 v[42:45], v[34:37], v[176:183], v7
    v_add_f32_dpp v55, v55, v55 row_ror:1 row_mask:0xf bank_mask:0xf
    v_smfmac_f32_16x16x64_bf16 v[42:45], v[38:41], v[184:191], v7
    s_mov_b32 exec_lo, 1
    s_mov_b32 exec_hi, 1
    ds_write_b32 v9, v55
    s_mov_b64 exec, s[50:51]
    s_nop 3
    ds_write_b128 v8, v[42:45]
    s_cmp_eq_u32 s23, 0
    s_cbranch_scc0 L_ncs
    s_mov_b64 exec, -1
    v_mov_b32 v46, 0
    v_mov_b32 v47, 0
    v_mov_b32 v48, 0
    v_mov_b32 v49, 0
    s_nop 1
    v_smfmac_f32_16x16x64_bf16 v[46:49], v[92:95], v[128:135], v7
    v_smfmac_f32_16x16x64_bf16 v[46:49], v[92:95], v[136:143], v7
    v_smfmac_f32_16x16x64_bf16 v[46:49], v[92:95], v[144:151], v7
    v_smfmac_f32_16x16x64_bf16 v[46:49], v[92:95], v[152:159], v7
    v_smfmac_f32_16x16x64_bf16 v[46:49], v[92:95], v[160:167], v7
    v_smfmac_f32_16x16x64_bf16 v[46:49], v[92:95], v[168:175], v7
    v_smfmac_f32_16x16x64_bf16 v[46:49], v[92:95], v[176:183], v7
    v_smfmac_f32_16x16x64_bf16 v[46:49], v[92:95], v[184:191], v7
    s_mov_b64 exec, s[50:51]
    s_nop 6
    ds_write_b128 v8, v[46:49] offset:2048
L_ncs:
    s_mov_b64 exec, -1
    s_waitcnt lgkmcnt(0)
    s_barrier
    s_cmp_eq_u32 s22, 0
    s_cbranch_scc0 L_Qnext
    s_and_b32 s26, s23, 1
    s_mul_i32 s26, s26, 4352
    v_add_u32 v10, s26, v58
    s_add_u32 s26, s26, 5120
    v_mov_b32 v11, s26
    s_cmp_eq_u32 s23, 0
    s_cbranch_scc0 L_Qr
    ds_read_b32 v125, v99
    ds_read2st64_b32 v[108:109], v10 offset0:8 offset1:9
    ds_read2st64_b32 v[110:111], v10 offset0:10 offset1:11
    ds_read2st64_b32 v[112:113], v10 offset0:12 offset1:13
    ds_read2st64_b32 v[114:115], v10 offset0:14 offset1:15
    s_waitcnt lgkmcnt(0)
    v_pk_add_f32 v[108:109], v[108:109], v[110:111]
    v_pk_add_f32 v[112:113], v[112:113], v[114:115]
    v_pk_add_f32 v[108:109], v[108:109], v[112:113]
    v_add_f32 v108, v108, v109
    v_mov_b32 v57, v108
L_Qr:
    ds_read_b128 v[116:119], v11
    ds_read_b128 v[120:123], v11 offset:16
    ds_read2st64_b32 v[100:101], v10 offset0:0 offset1:1
    ds_read2st64_b32 v[102:103], v10 offset0:2 offset1:3
    ds_read2st64_b32 v[104:105], v10 offset0:4 offset1:5
    ds_read2st64_b32 v[106:107], v10 offset0:6 offset1:7
    s_waitcnt lgkmcnt(4)
    v_pk_add_f32 v[116:117], v[116:117], v[118:119]
    v_pk_add_f32 v[120:121], v[120:121], v[122:123]
    v_pk_add_f32 v[116:117], v[116:117], v[120:121]
    v_mul_f32 v116, 0x3b124925, v116
    v_mul_f32 v117, 0x3b124925, v117
    v_fma_f32 v117, -v116, v116, v117
    v_max_f32 v117, 0, v117
    v_cvt_pk_bf16_f32 v118, v116, v117
    v_lshlrev_b32 v116, 16, v118
    v_and_b32 v117, 0xffff0000, v118
    v_add_f32 v117, 0x3727c5ac, v117
    v_cvt_pk_bf16_f32 v117, v117, v117
    v_and_b32 v117, 0xffff0000, v117
    v_sqrt_f32 v117, v117
    s_nop 0
    v_cvt_pk_bf16_f32 v117, v117, v117
    v_and_b32 v117, 0xffff0000, v117
    v_rcp_f32 v117, v117
    s_waitcnt lgkmcnt(0)
    v_pk_add_f32 v[100:101], v[100:101], v[102:103]
    v_pk_add_f32 v[104:105], v[104:105], v[106:107]
    v_pk_add_f32 v[100:101], v[100:101], v[104:105]
    v_add_f32 v100, v100, v101
    v_fma_f32 v100, -v116, v57, v100
    v_mul_f32 v100, v100, v117
    s_lshl_b32 s26, s23, 15
    s_add_u32 s27, s26, 8192
    v_mov_b32_dpp v101, v100 quad_perm:[1,0,3,2] row_mask:0xf bank_mask:0xf
    s_mov_b32 exec_lo, 0x55555555
    s_mov_b32 exec_hi, 0x55555555
    v_cvt_pk_bf16_f32 v124, v100, v101
    buffer_store_dwordx2 v[124:125], v59, s[4:7], s26 offen sc1
    buffer_store_dwordx2 v[124:125], v59, s[4:7], s27 offen sc1
    s_mov_b64 exec, -1
L_Qnext:
    s_add_u32 s23, s23, 1
    s_cmp_lt_i32 s23, 2
    s_cbranch_scc1 L_Qloop
    s_cmp_eq_u32 s21, 0
    s_cbranch_scc0 L_Qnx
    v_subrev_u32 v8, s20, v17
    v_min_u32 v9, -2, v24
    s_mov_b32 s26, 4294819840
    v_add_u32 v8, s26, v8
    s_mov_b32 s26, 8192
    s_mov_b64 exec, s[28:29]
    buffer_store_dword v9, v8, s[4:7], 0 offen sc1
    buffer_store_dword v9, v8, s[4:7], s26 offen sc1
    s_mov_b64 exec, -1
L_Qnx:
    s_cmp_lt_u32 s21, 7
    s_cbranch_scc0 L_exit
    s_cmp_eq_u32 s22, 0
    s_cbranch_scc0 L_exit
    s_mov_b32 s16, s82
    s_mov_b32 s17, s83
    s_mov_b32 s18, 896
    s_mov_b32 s19, 0x20000
    v_lshrrev_b32 v8, 3, v0
    v_lshlrev_b32 v8, 10, v8
    v_and_b32 v9, 7, v0
    v_lshl_add_u32 v8, v9, 4, v8
    s_lshl_b32 s26, s21, 7
    s_add_u32 s27, s26, s20
    v_add_u32 v16, s27, v8
    v_add_u32 v97, s26, v14
    s_add_u32 s27, s27, 1736704
    v_add_u32 v17, s27, v14
    v_mov_b32 v22, 0
    v_mov_b32 v72, 0
    v_mov_b32 v73, 0
    v_mov_b32 v74, 0
    v_mov_b32 v75, 0
    s_mov_b32 s32, 1654784
    s_mov_b32 s33, 1671168
    s_mov_b32 s34, 1687552
    s_mov_b32 s35, 1703936
    s_mov_b32 s28, 0x00ff00ff
    s_mov_b32 s29, 0x00ff00ff
    s_mov_b32 s25, 0
L_Fp:
    s_mov_b64 exec, s[28:29]
    buffer_load_dword v22, v17, s[4:7], 0 offen sc1
    s_mov_b64 exec, -1
    buffer_load_dwordx4 v[60:63], v16, s[4:7], s32 offen sc1
    buffer_load_dwordx4 v[64:67], v16, s[4:7], s33 offen sc1
    buffer_load_dwordx4 v[68:71], v16, s[4:7], s34 offen sc1
    s_mov_b32 exec_hi, 0
    buffer_load_dwordx4 v[72:75], v16, s[4:7], s35 offen sc1
    s_mov_b64 exec, -1
    s_add_u32 s25, s25, 1
    s_cmp_gt_u32 s25, 20000
    s_cbranch_scc1 L_exit
    v_mov_b32 v42, 0
    v_mov_b32 v43, 0
    v_mov_b32 v44, 0
    v_mov_b32 v45, 0
    s_waitcnt vmcnt(2)
    s_nop 0
    v_smfmac_f32_16x16x64_bf16 v[42:45], v[92:95], v[60:67], v7
    v_max3_u32 v54, v22, v60, v64
    v_lshlrev_b32 v52, 16, v22
    v_and_b32 v53, 0xffff0000, v22
    s_waitcnt vmcnt(0)
    v_smfmac_f32_16x16x64_bf16 v[42:45], v[92:95], v[68:75], v7
    v_max3_u32 v54, v54, v68, v72
    v_cmp_eq_u32 vcc, -1, v54
    s_nop 0
    s_cbranch_vccnz L_Fp
    s_nop 3
    v_cndmask_b32 v50, v42, v44, s[48:49]
    v_cndmask_b32 v51, v43, v45, s[48:49]
    s_nop 0
    v_add_f32_dpp v50, v50, v50 row_ror:8 row_mask:0xf bank_mask:0xf
    v_add_f32_dpp v51, v51, v51 row_ror:8 row_mask:0xf bank_mask:0xf
    v_cvt_pk_bf16_f32 v55, v50, v51
    v_lshlrev_b32 v50, 16, v55
    v_and_b32 v51, 0xffff0000, v55
    v_pk_add_f32 v[50:51], v[50:51], v[52:53]
    v_cvt_pk_bf16_f32 v50, v50, v51
    s_mov_b64 exec, s[28:29]
    buffer_store_dword v50, v97, s[16:19], 0 offen
    s_cmp_eq_u32 s21, 0
    s_cbranch_scc0 L_exit
    v_mov_b32 v9, s24
    v_mov_b32 v8, 0
    s_mov_b64 exec, 1
    buffer_store_dword v9, v8, s[4:7], 0 offen sc1
    s_branch L_exit
L_Qh:
    s_waitcnt lgkmcnt(0)
    s_mov_b32 s4, s86
    s_mov_b32 s5, s87
    s_mov_b32 s6, 2097152
    s_mov_b32 s7, 0x20000
    v_mov_b32 v8, 0
    buffer_load_dword v9, v8, s[4:7], 0 offen sc1
    v_mov_b32 v12, -1
    v_mov_b32 v13, -1
    v_mov_b32 v14, -1
    v_mov_b32 v15, -1
    v_lshlrev_b32 v10, 4, v0
    s_cmp_eq_u32 s21, 0
    s_cbranch_scc0 L_Qh1
    s_mov_b32 s30, 1572864
    buffer_store_dwordx4 v[12:15], v10, s[4:7], s30 offen sc1
    s_add_u32 s31, s30, 8192
    buffer_store_dwordx4 v[12:15], v10, s[4:7], s31 offen sc1
L_Qh1:
    s_waitcnt vmcnt(0)
    v_readfirstlane_b32 s24, v9
    s_nop 0
    s_mul_i32 s24, s24, 0x9E3779B1
    s_add_u32 s24, s24, 0x7F4A7C15
    s_lshr_b32 s26, s2, 7
    s_lshl_b32 s26, s26, 14
    s_and_b32 s27, s2, 127
    s_lshl_b32 s27, s27, 6
    s_add_u32 s26, s26, s27
    s_add_u32 s26, s26, 16384
    v_mov_b32 v8, 0
    v_mov_b32 v11, s24
    s_mov_b64 exec, 1
    buffer_store_dword v11, v8, s[4:7], s26 offen sc1
    s_mov_b64 exec, -1
    v_mov_b32 v16, 12288
    ds_write_b32 v16, v11
    s_waitcnt lgkmcnt(0)
    s_branch L_exit
L_W:
    s_sub_u32 s21, s2, 193
    s_lshr_b32 s27, s21, 2
    s_lshl_b32 s27, s27, 14
    s_and_b32 s26, s21, 3
    s_lshl_b32 s26, s26, 11
    s_add_u32 s53, s26, s27
    s_lshr_b32 s27, s21, 3
    s_lshl_b32 s27, s27, 14
    s_and_b32 s26, s21, 7
    s_lshl_b32 s26, s26, 10
    s_add_u32 s52, s26, s27
    s_add_u32 s52, s52, 1441792
    s_cmp_gt_u32 s22, 4
    s_cbranch_scc1 L_exit
    s_cmp_eq_u32 s22, 4
    s_cbranch_scc1 L_Wh
    s_waitcnt lgkmcnt(0)
    s_mov_b32 s4, s86
    s_mov_b32 s5, s87
    s_mov_b32 s6, 2097152
    s_mov_b32 s7, 0x20000
    s_mul_i32 s27, s21, 114688
    s_add_u32 s8, s72, s27
    s_addc_u32 s9, s73, 0
    s_mov_b32 s10, 114688
    s_mov_b32 s11, 0x20000
    v_lshrrev_b32 v8, 1, v2
    v_mul_u32_u24 v8, 32, v8
    v_and_b32 v9, 1, v2
    v_add_u32 v8, v8, v9
    v_mul_u32_u24 v8, 896, v8
    v_lshl_add_u32 v8, v1, 4, v8
    s_lshl_b32 s26, s22, 8
    v_add_u32 v16, s26, v8
    s_cmp_eq_u32 s22, 3
    s_cselect_b32 s28, 0x00ff00ff, -1
    s_mov_b32 s29, s28
    s_mov_b64 exec, s[28:29]
    s_mov_b32 s26, 0
    s_waitcnt vmcnt(1)
    buffer_load_dwordx4 v[128:131], v16, s[8:11], s26 offen nt
    s_mov_b32 s26, 57344
    s_waitcnt vmcnt(1)
    buffer_load_dwordx4 v[132:135], v16, s[8:11], s26 offen nt
    s_mov_b32 s26, 1792
    s_waitcnt vmcnt(1)
    buffer_load_dwordx4 v[136:139], v16, s[8:11], s26 offen nt
    s_mov_b32 s26, 59136
    s_waitcnt vmcnt(1)
    buffer_load_dwordx4 v[140:143], v16, s[8:11], s26 offen nt
    s_mov_b32 s26, 3584
    s_waitcnt vmcnt(1)
    buffer_load_dwordx4 v[144:147], v16, s[8:11], s26 offen nt
    s_mov_b32 s26, 60928
    s_waitcnt vmcnt(1)
    buffer_load_dwordx4 v[148:151], v16, s[8:11], s26 offen nt
    s_mov_b32 s26, 5376
    s_waitcnt vmcnt(1)
    buffer_load_dwordx4 v[152:155], v16, s[8:11], s26 offen nt
    s_mov_b32 s26, 62720
    s_waitcnt vmcnt(1)
    buffer_load_dwordx4 v[156:159], v16, s[8:11], s26 offen nt
    s_mov_b32 s26, 7168
    s_waitcnt vmcnt(1)
    buffer_load_dwordx4 v[160:163], v16, s[8:11], s26 offen nt
    s_mov_b32 s26, 64512
    buffer_load_dwordx4 v[164:167], v16, s[8:11], s26 offen nt
    s_mov_b32 s26, 8960
    buffer_load_dwordx4 v[168:171], v16, s[8:11], s26 offen nt
    s_mov_b32 s26, 66304
    buffer_load_dwordx4 v[172:175], v16, s[8:11], s26 offen nt
    s_mov_b32 s26, 10752
    buffer_load_dwordx4 v[176:179], v16, s[8:11], s26 offen nt
    s_mov_b32 s26, 68096
    buffer_load_dwordx4 v[180:183], v16, s[8:11], s26 offen nt
    s_mov_b32 s26, 12544
    buffer_load_dwordx4 v[184:187], v16, s[8:11], s26 offen nt
    s_mov_b32 s26, 69888
    buffer_load_dwordx4 v[188:191], v16, s[8:11], s26 offen nt
    s_mov_b32 s26, 14336
    buffer_load_dwordx4 v[192:195], v16, s[8:11], s26 offen nt
    s_mov_b32 s26, 71680
    buffer_load_dwordx4 v[196:199], v16, s[8:11], s26 offen nt
    s_mov_b32 s26, 16128
    buffer_load_dwordx4 v[200:203], v16, s[8:11], s26 offen nt
    s_mov_b32 s26, 73472
    buffer_load_dwordx4 v[204:207], v16, s[8:11], s26 offen nt
    s_mov_b32 s26, 17920
    buffer_load_dwordx4 v[208:211], v16, s[8:11], s26 offen nt
    s_mov_b32 s26, 75264
    buffer_load_dwordx4 v[212:215], v16, s[8:11], s26 offen nt
    s_mov_b32 s26, 19712
    buffer_load_dwordx4 v[216:219], v16, s[8:11], s26 offen nt
    s_mov_b32 s26, 77056
    buffer_load_dwordx4 v[220:223], v16, s[8:11], s26 offen nt
    s_mov_b32 s26, 21504
    buffer_load_dwordx4 v[224:227], v16, s[8:11], s26 offen nt
    s_mov_b32 s26, 78848
    buffer_load_dwordx4 v[228:231], v16, s[8:11], s26 offen nt
    s_mov_b32 s26, 23296
    buffer_load_dwordx4 v[232:235], v16, s[8:11], s26 offen nt
    s_mov_b32 s26, 80640
    buffer_load_dwordx4 v[236:239], v16, s[8:11], s26 offen nt
    s_mov_b32 s26, 25088
    buffer_load_dwordx4 v[240:243], v16, s[8:11], s26 offen nt
    s_mov_b32 s26, 82432
    buffer_load_dwordx4 v[244:247], v16, s[8:11], s26 offen nt
    s_mov_b32 s26, 26880
    buffer_load_dwordx4 v[248:251], v16, s[8:11], s26 offen nt
    s_mov_b32 s26, 84224
    buffer_load_dwordx4 v[252:255], v16, s[8:11], s26 offen nt
    s_mov_b64 exec, -1
    v_and_b32 v8, 4, v1
    v_cmp_eq_u32 vcc, 0, v8
    v_mov_b32 v9, 0xffff
    s_nop 0
    v_cndmask_b32 v3, 0, v9, vcc
    v_xor_b32 v4, v3, v9
    v_lshlrev_b32 v5, 16, v3
    v_lshlrev_b32 v6, 16, v4
    v_and_b32 v8, 3, v1
    v_mul_u32_u24 v7, 17425, v8
    v_xor_b32 v8, 1, v8
    v_mul_u32_u24 v8, 4420, v8
    v_add_u32 v7, v7, v8
    v_lshrrev_b32 v9, 1, v2
    v_lshlrev_b32 v9, 13, v9
    v_lshl_add_u32 v8, v1, 4, v9
    s_lshl_b32 s26, s22, 8
    s_add_u32 s26, s26, s52
    v_add_u32 v17, s26, v8
    s_and_b32 s46, s28, 0xffff
    s_mov_b32 s47, s46
    v_lshrrev_b32 v8, 2, v0
    v_and_b32 v9, 3, v0
    v_lshlrev_b32 v10, 9, v8
    v_lshl_add_u32 v10, v9, 5, v10
    s_lshl_b32 s26, s21, 14
    s_lshl_b32 s27, s22, 7
    s_add_u32 s26, s26, s27
    s_add_u32 s26, s26, 131072
    v_add_u32 v18, s26, v10
    s_add_u32 s26, s53, 1179648
    v_lshl_add_u32 v19, v8, 7, s26
    v_lshlrev_b32 v10, 4, v9
    v_lshl_add_u32 v10, v2, 2, v10
    s_lshl_b32 s26, s22, 6
    v_add_u32 v20, s26, v10
    v_lshlrev_b32 v21, 6, v2
    s_mov_b32 s23, 0
    s_waitcnt vmcnt(0)
    v_mov_b32 v8, 512
    s_barrier
    ds_read_b32 v9, v8
    s_waitcnt lgkmcnt(0)
    v_add_u32 v18, v9, v18
    v_add_u32 v19, v9, v19
L_Wl:
    s_mov_b32 s25, 0
    s_mul_i32 s30, s23, 524288
    s_lshl_b32 s27, s23, 17
    s_lshl_b32 s31, s23, 16
L_Wp:
    buffer_load_dwordx2 v[22:23], v19, s[4:7], s27 offen sc1
    buffer_load_dwordx4 v[60:63], v18, s[4:7], s30 offen sc1
    buffer_load_dwordx4 v[64:67], v18, s[4:7], s30 offen offset:16 sc1
    s_add_u32 s25, s25, 1
    s_cmp_gt_u32 s25, 20000
    s_cbranch_scc1 L_exit
    s_waitcnt vmcnt(2)
    v_max_f32_dpp v24, v22, v22 row_ror:4 row_mask:0xf bank_mask:0xf
    s_nop 1
    v_max_f32_dpp v24, v24, v24 row_ror:8 row_mask:0xf bank_mask:0xf
    v_mov_b32 v25, v24
    s_nop 1
    v_permlane16_swap_b32 v24, v25
    v_max_f32 v24, v24, v25
    v_mov_b32 v25, v24
    s_nop 1
    v_permlane32_swap_b32 v24, v25
    v_max_f32 v24, v24, v25
    v_sub_f32 v24, v22, v24
    v_exp_f32 v24, v24
    s_waitcnt vmcnt(0)
    v_max3_u32 v54, v22, v60, v64
    v_cmp_eq_u32 vcc, -1, v54
    s_nop 0
    s_cbranch_vccnz L_Wp
    v_mul_f32 v26, v23, v24
    v_pk_mul_f32 v[60:61], v[60:61], v[24:25] op_sel_hi:[1,0]
    v_pk_mul_f32 v[64:65], v[64:65], v[24:25] op_sel_hi:[1,0]
    v_pk_mul_f32 v[62:63], v[62:63], v[24:25] op_sel_hi:[1,0]
    v_pk_mul_f32 v[66:67], v[66:67], v[24:25] op_sel_hi:[1,0]
    v_add_f32_dpp v26, v26, v26 row_ror:4 row_mask:0xf bank_mask:0xf
    v_permlane32_swap_b32 v60, v64
    v_permlane32_swap_b32 v61, v65
    v_add_f32_dpp v26, v26, v26 row_ror:8 row_mask:0xf bank_mask:0xf
    v_permlane32_swap_b32 v62, v66
    v_permlane32_swap_b32 v63, v67
    v_mov_b32 v27, v26
    v_pk_add_f32 v[60:61], v[60:61], v[64:65]
    v_pk_add_f32 v[62:63], v[62:63], v[66:67]
    v_permlane16_swap_b32 v26, v27
    v_add_f32 v26, v26, v27
    v_permlane16_swap_b32 v60, v62
    v_permlane16_swap_b32 v61, v63
    v_mov_b32 v27, v26
    v_pk_add_f32 v[60:61], v[60:61], v[62:63]
    s_nop 0
    v_permlane32_swap_b32 v26, v27
    v_add_f32_dpp v60, v60, v60 row_ror:4 row_mask:0xf bank_mask:0xf
    v_add_f32_dpp v61, v61, v61 row_ror:4 row_mask:0xf bank_mask:0xf
    v_add_f32 v26, v26, v27
    v_rcp_f32 v26, v26
    v_add_f32_dpp v60, v60, v60 row_ror:8 row_mask:0xf bank_mask:0xf
    v_add_f32_dpp v61, v61, v61 row_ror:8 row_mask:0xf bank_mask:0xf
    v_pk_mul_f32 v[60:61], v[60:61], v[26:27] op_sel_hi:[1,0]
    v_cvt_pk_bf16_f32 v60, v60, v61
    ds_write_b32 v20, v60
    s_waitcnt lgkmcnt(0)
    s_barrier
    ds_read_b128 v[60:63], v21
    ds_read_b128 v[64:67], v21 offset:16
    ds_read_b128 v[68:71], v21 offset:32
    ds_read_b128 v[72:75], v21 offset:48
    v_mov_b32 v42, 0
    v_mov_b32 v43, 0
    v_mov_b32 v44, 0
    v_mov_b32 v45, 0
    s_waitcnt lgkmcnt(3)
    v_and_b32 v34, v60, v3
    v_and_b32 v35, v60, v4
    v_and_b32 v36, v60, v5
    v_and_b32 v37, v60, v6
    v_and_b32 v38, v61, v3
    v_and_b32 v39, v61, v4
    v_and_b32 v40, v61, v5
    v_and_b32 v41, v61, v6
    v_smfmac_f32_16x16x64_bf16 v[42:45], v[34:37], v[128:135], v7
    v_and_b32 v34, v62, v3
    v_and_b32 v35, v62, v4
    v_and_b32 v36, v62, v5
    v_and_b32 v37, v62, v6
    v_smfmac_f32_16x16x64_bf16 v[42:45], v[38:41], v[136:143], v7
    v_and_b32 v38, v63, v3
    v_and_b32 v39, v63, v4
    v_and_b32 v40, v63, v5
    v_and_b32 v41, v63, v6
    v_smfmac_f32_16x16x64_bf16 v[42:45], v[34:37], v[144:151], v7
    s_waitcnt lgkmcnt(2)
    v_and_b32 v34, v64, v3
    v_and_b32 v35, v64, v4
    v_and_b32 v36, v64, v5
    v_and_b32 v37, v64, v6
    v_smfmac_f32_16x16x64_bf16 v[42:45], v[38:41], v[152:159], v7
    v_and_b32 v38, v65, v3
    v_and_b32 v39, v65, v4
    v_and_b32 v40, v65, v5
    v_and_b32 v41, v65, v6
    v_smfmac_f32_16x16x64_bf16 v[42:45], v[34:37], v[160:167], v7
    v_and_b32 v34, v66, v3
    v_and_b32 v35, v66, v4
    v_and_b32 v36, v66, v5
    v_and_b32 v37, v66, v6
    v_smfmac_f32_16x16x64_bf16 v[42:45], v[38:41], v[168:175], v7
    v_and_b32 v38, v67, v3
    v_and_b32 v39, v67, v4
    v_and_b32 v40, v67, v5
    v_and_b32 v41, v67, v6
    v_smfmac_f32_16x16x64_bf16 v[42:45], v[34:37], v[176:183], v7
    s_waitcnt lgkmcnt(1)
    v_and_b32 v34, v68, v3
    v_and_b32 v35, v68, v4
    v_and_b32 v36, v68, v5
    v_and_b32 v37, v68, v6
    v_smfmac_f32_16x16x64_bf16 v[42:45], v[38:41], v[184:191], v7
    v_and_b32 v38, v69, v3
    v_and_b32 v39, v69, v4
    v_and_b32 v40, v69, v5
    v_and_b32 v41, v69, v6
    v_smfmac_f32_16x16x64_bf16 v[42:45], v[34:37], v[192:199], v7
    v_and_b32 v34, v70, v3
    v_and_b32 v35, v70, v4
    v_and_b32 v36, v70, v5
    v_and_b32 v37, v70, v6
    v_smfmac_f32_16x16x64_bf16 v[42:45], v[38:41], v[200:207], v7
    v_and_b32 v38, v71, v3
    v_and_b32 v39, v71, v4
    v_and_b32 v40, v71, v5
    v_and_b32 v41, v71, v6
    v_smfmac_f32_16x16x64_bf16 v[42:45], v[34:37], v[208:215], v7
    s_waitcnt lgkmcnt(0)
    v_and_b32 v34, v72, v3
    v_and_b32 v35, v72, v4
    v_and_b32 v36, v72, v5
    v_and_b32 v37, v72, v6
    v_smfmac_f32_16x16x64_bf16 v[42:45], v[38:41], v[216:223], v7
    v_and_b32 v38, v73, v3
    v_and_b32 v39, v73, v4
    v_and_b32 v40, v73, v5
    v_and_b32 v41, v73, v6
    v_smfmac_f32_16x16x64_bf16 v[42:45], v[34:37], v[224:231], v7
    v_and_b32 v34, v74, v3
    v_and_b32 v35, v74, v4
    v_and_b32 v36, v74, v5
    v_and_b32 v37, v74, v6
    v_smfmac_f32_16x16x64_bf16 v[42:45], v[38:41], v[232:239], v7
    v_and_b32 v38, v75, v3
    v_and_b32 v39, v75, v4
    v_and_b32 v40, v75, v5
    v_and_b32 v41, v75, v6
    v_smfmac_f32_16x16x64_bf16 v[42:45], v[34:37], v[240:247], v7
    s_nop 0
    v_smfmac_f32_16x16x64_bf16 v[42:45], v[38:41], v[248:255], v7
    s_nop 7
    v_cvt_pk_bf16_f32 v46, v42, v43
    v_cvt_pk_bf16_f32 v48, v42, v43
    v_cvt_pk_bf16_f32 v47, v44, v45
    v_cvt_pk_bf16_f32 v49, v44, v45
    v_permlane16_swap_b32 v46, v48
    s_nop 0
    v_permlane16_swap_b32 v47, v49
    s_mov_b64 exec, s[46:47]
    v_min_u32 v46, -2, v46
    buffer_store_dwordx4 v[46:49], v17, s[4:7], s31 offen sc1
    s_mov_b64 exec, -1
    s_cmp_eq_u32 s23, 1
    s_cbranch_scc1 L_exit
    s_mov_b32 s23, 1
    s_branch L_Wl
L_Wh:
    s_waitcnt lgkmcnt(0)
    s_mov_b32 s4, s86
    s_mov_b32 s5, s87
    s_mov_b32 s6, 2097152
    s_mov_b32 s7, 0x20000
    v_mov_b32 v8, 0
    buffer_load_dword v9, v8, s[4:7], 0 offen sc1
    v_mov_b32 v12, -1
    v_mov_b32 v13, -1
    v_mov_b32 v14, -1
    v_mov_b32 v15, -1
    v_lshlrev_b32 v10, 4, v0
    buffer_store_dwordx4 v[12:15], v10, s[4:7], s52 offen sc1
    s_add_u32 s31, s52, 8192
    buffer_store_dwordx4 v[12:15], v10, s[4:7], s31 offen sc1
    s_add_u32 s53, s52, 65536
    buffer_store_dwordx4 v[12:15], v10, s[4:7], s53 offen sc1
    s_add_u32 s31, s53, 8192
    buffer_store_dwordx4 v[12:15], v10, s[4:7], s31 offen sc1
    s_waitcnt vmcnt(0)
    v_readfirstlane_b32 s24, v9
    s_nop 0
    s_mul_i32 s24, s24, 0x9E3779B1
    s_add_u32 s24, s24, 0x7F4A7C15
    s_lshr_b32 s26, s2, 7
    s_lshl_b32 s26, s26, 14
    s_and_b32 s27, s2, 127
    s_lshl_b32 s27, s27, 6
    s_add_u32 s26, s26, s27
    s_add_u32 s26, s26, 16384
    v_mov_b32 v8, 0
    v_mov_b32 v11, s24
    s_mov_b64 exec, 1
    buffer_store_dword v11, v8, s[4:7], s26 offen sc1
    s_mov_b64 exec, -1
    s_lshr_b32 s27, s21, 2
    s_lshl_b32 s27, s27, 4
    s_add_u32 s27, s27, 65
    v_add_u32 v8, s27, v0
    v_cmp_ne_u32 vcc, 16, v0
    s_nop 1
    v_cndmask_b32 v8, 0, v8, vcc
    v_cndmask_b32_e64 v9, 1, 0, vcc
    v_lshrrev_b32 v11, 7, v8
    v_lshlrev_b32 v11, 14, v11
    v_and_b32 v8, 127, v8
    v_lshl_add_u32 v8, v8, 6, v11
    s_mov_b32 s26, 16384
    s_mov_b32 s25, 0
    s_mov_b32 exec_lo, 0x1ffff
    s_mov_b32 exec_hi, 0x0
L_fp_w:
    buffer_load_dword v11, v8, s[4:7], s26 offen sc1
    s_add_u32 s25, s25, 1
    s_cmp_gt_u32 s25, 20000
    s_cbranch_scc1 L_exit
    s_waitcnt vmcnt(0)
    v_xor_b32 v11, s24, v11
    v_cmp_gt_u32 vcc, v11, v9
    s_nop 0
    s_cbranch_vccnz L_fp_w
    v_readlane_b32 s26, v11, 16
    s_mov_b64 exec, -1
    s_lshl_b32 s26, s26, 13
    s_xor_b32 s20, s20, s26
    v_mov_b32 v8, 512
    v_mov_b32 v9, s20
    ds_write_b32 v8, v9
    s_waitcnt lgkmcnt(0)
    s_branch L_exit
L_C:
    s_cmp_eq_u32 s22, 0
    s_cbranch_scc0 L_exit
    s_setprio 3
    s_waitcnt lgkmcnt(0)
    s_mov_b32 s4, s86
    s_mov_b32 s5, s87
    s_mov_b32 s6, 2097152
    s_mov_b32 s7, 0x20000
    v_mov_b32 v8, 0
    buffer_load_dword v9, v8, s[4:7], 0 offen sc1
    v_mov_b32 v12, -1
    v_mov_b32 v13, -1
    v_mov_b32 v14, -1
    v_mov_b32 v15, -1
    s_mov_b32 s26, 1753088
    s_mov_b32 s27, 1761280
    v_lshlrev_b32 v17, 8, v0
    s_mov_b64 exec, 0x1
    buffer_store_dword v8, v17, s[4:7], s26 offen offset:0 sc1
    buffer_store_dword v8, v17, s[4:7], s27 offen offset:0 sc1
    s_mov_b64 exec, 1
    s_mov_b32 s32, -1
    s_mov_b32 s33, -1
    s_waitcnt vmcnt(0)
    s_mov_b32 s30, 0
L_Cl:
    s_add_u32 s26, s26, 256
    s_add_u32 s27, s27, 256
    s_memtime s[36:37]
    s_waitcnt lgkmcnt(0)
    buffer_store_dword v8, v8, s[4:7], s26 offen offset:128 sc1
    s_waitcnt vmcnt(0)
    s_memtime s[38:39]
    s_waitcnt lgkmcnt(0)
    buffer_store_dword v8, v8, s[4:7], s27 offen offset:128 sc1
    s_waitcnt vmcnt(0)
    s_memtime s[40:41]
    s_waitcnt lgkmcnt(0)
    s_sub_u32 s34, s38, s36
    s_sub_u32 s35, s40, s38
    s_min_u32 s32, s32, s34
    s_min_u32 s33, s33, s35
    s_add_u32 s30, s30, 1
    s_cmp_ge_u32 s30, 8
    s_cbranch_scc1 L_Cd
    s_min_u32 s34, s32, s33
    s_max_u32 s35, s32, s33
    s_sub_u32 s35, s35, s34
    s_cmp_ge_u32 s30, 99
    s_cselect_b32 s34, 0, s34
    s_cmp_le_u32 s34, 600
    s_cselect_b32 s35, s35, 0
    s_cmp_ge_u32 s30, 2
    s_cselect_b32 s35, s35, 0
    s_cmp_ge_u32 s35, 100
    s_cbranch_scc0 L_Cl
L_Cd:
    s_mov_b64 exec, -1
    s_cmp_lt_u32 s33, s32
    s_cselect_b32 s30, 1, 0
    s_lshr_b32 s31, s20, 13
    s_xor_b32 s30, s30, s31
    s_waitcnt vmcnt(0)
    v_readfirstlane_b32 s24, v9
    s_nop 0
    s_mul_i32 s24, s24, 0x9E3779B1
    s_add_u32 s24, s24, 0x7F4A7C15
    s_xor_b32 s24, s24, s30
    s_lshr_b32 s26, s2, 7
    s_lshl_b32 s26, s26, 14
    s_and_b32 s27, s2, 127
    s_lshl_b32 s27, s27, 6
    s_add_u32 s26, s26, s27
    s_add_u32 s26, s26, 16384
    v_mov_b32 v8, 0
    v_mov_b32 v11, s24
    s_mov_b64 exec, 1
    buffer_store_dword v11, v8, s[4:7], s26 offen sc1
    s_mov_b64 exec, -1
    s_branch L_exit
L_F:
    s_sub_u32 s21, s2, 225
    s_waitcnt lgkmcnt(0)
    s_mov_b32 s4, s86
    s_mov_b32 s5, s87
    s_mov_b32 s6, 2097152
    s_mov_b32 s7, 0x20000
    s_cmp_gt_u32 s22, 3
    s_cbranch_scc1 L_Fb
    s_mov_b32 s16, s64
    s_mov_b32 s17, s65
    s_mov_b32 s18, 896
    s_mov_b32 s19, 0x20000
    s_lshl_b32 s27, s21, 7
    s_add_u32 s8, s76, s27
    s_addc_u32 s9, s77, 0
    s_mov_b32 s10, 1605632
    s_mov_b32 s11, 0x20000
    s_sub_u32 s10, s10, s27
    s_add_u32 s12, s78, s27
    s_addc_u32 s13, s79, 0
    s_mov_b32 s14, 1605632
    s_mov_b32 s15, 0x20000
    s_sub_u32 s14, s14, s27
    v_and_b32 v8, 1, v2
    v_lshlrev_b32 v8, 3, v8
    v_lshl_add_u32 v8, v1, 4, v8
    v_lshrrev_b32 v9, 1, v2
    v_lshl_add_u32 v14, v9, 2, v8
    s_lshl_b32 s26, s22, 8
    buffer_load_dword v25, v14, s[16:19], s26 offen
    v_lshrrev_b32 v8, 1, v2
    v_lshrrev_b32 v9, 3, v1
    v_lshl_add_u32 v8, v8, 1, v9
    v_and_b32 v9, 1, v2
    v_lshl_add_u32 v8, v8, 4, v9
    s_lshl_b32 s26, s22, 7
    v_add_u32 v8, s26, v8
    v_mul_u32_u24 v8, 3584, v8
    v_and_b32 v9, 7, v1
    v_lshl_add_u32 v15, v9, 4, v8
    s_mov_b32 s26, 0
    s_waitcnt vmcnt(0)
    buffer_load_dwordx4 v[128:131], v15, s[8:11], s26 offen nt
    s_mov_b32 s26, 229376
    s_waitcnt vmcnt(0)
    buffer_load_dwordx4 v[132:135], v15, s[8:11], s26 offen nt
    s_mov_b32 s26, 7168
    s_waitcnt vmcnt(0)
    buffer_load_dwordx4 v[136:139], v15, s[8:11], s26 offen nt
    s_mov_b32 s26, 236544
    s_waitcnt vmcnt(0)
    buffer_load_dwordx4 v[140:143], v15, s[8:11], s26 offen nt
    s_mov_b32 s26, 14336
    buffer_load_dwordx4 v[144:147], v15, s[8:11], s26 offen nt
    s_mov_b32 s26, 243712
    buffer_load_dwordx4 v[148:151], v15, s[8:11], s26 offen nt
    s_mov_b32 s26, 21504
    buffer_load_dwordx4 v[152:155], v15, s[8:11], s26 offen nt
    s_mov_b32 s26, 250880
    buffer_load_dwordx4 v[156:159], v15, s[8:11], s26 offen nt
    s_mov_b32 s26, 28672
    buffer_load_dwordx4 v[160:163], v15, s[8:11], s26 offen nt
    s_mov_b32 s26, 258048
    buffer_load_dwordx4 v[164:167], v15, s[8:11], s26 offen nt
    s_mov_b32 s26, 35840
    buffer_load_dwordx4 v[168:171], v15, s[8:11], s26 offen nt
    s_mov_b32 s26, 265216
    buffer_load_dwordx4 v[172:175], v15, s[8:11], s26 offen nt
    s_mov_b32 s26, 43008
    buffer_load_dwordx4 v[176:179], v15, s[8:11], s26 offen nt
    s_mov_b32 s26, 272384
    buffer_load_dwordx4 v[180:183], v15, s[8:11], s26 offen nt
    s_mov_b32 s26, 50176
    buffer_load_dwordx4 v[184:187], v15, s[8:11], s26 offen nt
    s_mov_b32 s26, 279552
    buffer_load_dwordx4 v[188:191], v15, s[8:11], s26 offen nt
    s_mov_b32 s26, 0
    buffer_load_dwordx4 v[192:195], v15, s[12:15], s26 offen nt
    s_mov_b32 s26, 229376
    buffer_load_dwordx4 v[196:199], v15, s[12:15], s26 offen nt
    s_mov_b32 s26, 7168
    buffer_load_dwordx4 v[200:203], v15, s[12:15], s26 offen nt
    s_mov_b32 s26, 236544
    buffer_load_dwordx4 v[204:207], v15, s[12:15], s26 offen nt
    s_mov_b32 s26, 14336
    buffer_load_dwordx4 v[208:211], v15, s[12:15], s26 offen nt
    s_mov_b32 s26, 243712
    buffer_load_dwordx4 v[212:215], v15, s[12:15], s26 offen nt
    s_mov_b32 s26, 21504
    buffer_load_dwordx4 v[216:219], v15, s[12:15], s26 offen nt
    s_mov_b32 s26, 250880
    buffer_load_dwordx4 v[220:223], v15, s[12:15], s26 offen nt
    s_mov_b32 s26, 28672
    buffer_load_dwordx4 v[224:227], v15, s[12:15], s26 offen nt
    s_mov_b32 s26, 258048
    buffer_load_dwordx4 v[228:231], v15, s[12:15], s26 offen nt
    s_mov_b32 s26, 35840
    buffer_load_dwordx4 v[232:235], v15, s[12:15], s26 offen nt
    s_mov_b32 s26, 265216
    buffer_load_dwordx4 v[236:239], v15, s[12:15], s26 offen nt
    s_mov_b32 s26, 43008
    buffer_load_dwordx4 v[240:243], v15, s[12:15], s26 offen nt
    s_mov_b32 s26, 272384
    buffer_load_dwordx4 v[244:247], v15, s[12:15], s26 offen nt
    s_mov_b32 s26, 50176
    buffer_load_dwordx4 v[248:251], v15, s[12:15], s26 offen nt
    s_mov_b32 s26, 279552
    buffer_load_dwordx4 v[252:255], v15, s[12:15], s26 offen nt
    v_and_b32 v8, 4, v1
    v_cmp_eq_u32 vcc, 0, v8
    v_mov_b32 v9, 0xffff
    s_nop 0
    v_cndmask_b32 v3, 0, v9, vcc
    v_xor_b32 v4, v3, v9
    v_lshlrev_b32 v5, 16, v3
    v_lshlrev_b32 v6, 16, v4
    v_and_b32 v8, 3, v1
    v_mul_u32_u24 v7, 17425, v8
    v_xor_b32 v8, 1, v8
    v_mul_u32_u24 v8, 4420, v8
    v_add_u32 v7, v7, v8
    s_mov_b32 s50, 0x00ff00ff
    s_mov_b32 s51, 0xff00ff00
    s_mov_b32 s48, 0
    s_mov_b32 s49, -1
    s_cmp_eq_u32 s22, 3
    s_cselect_b32 s28, 0x00ff00ff, -1
    s_mov_b32 s29, s28
    s_lshl_b32 s26, s22, 8
    v_lshlrev_b32 v8, 10, v2
    v_lshl_add_u32 v8, v1, 4, v8
    v_add_u32 v16, s26, v8
    v_add_u32 v18, s26, v14
    s_add_u32 s27, s26, 1572864
    v_add_u32 v17, s27, v14
    v_lshrrev_b32 v11, 3, v0
    v_lshl_add_u32 v19, v11, 5, s26
    v_lshlrev_b32 v8, 14, v11
    v_and_b32 v9, 7, v0
    v_lshl_add_u32 v8, v9, 10, v8
    s_add_u32 s27, s26, 1441792
    v_add_u32 v13, s27, v8
    v_lshrrev_b32 v11, 3, v1
    v_lshlrev_b32 v11, 8, v11
    v_and_b32 v12, 7, v1
    v_lshl_add_u32 v11, v12, 5, v11
    v_and_b32 v12, 1, v2
    v_lshl_add_u32 v11, v12, 4, v11
    s_lshl_b32 s26, s22, 9
    s_add_u32 s26, s26, 1024
    v_add_u32 v20, s26, v11
    s_lshl_b32 s26, s22, 3
    s_add_u32 s26, s26, 5120
    v_lshrrev_b32 v8, 5, v0
    v_lshl_add_u32 v21, v8, 2, s26
    v_and_b32 v92, 0x3f803f80, v3
    v_and_b32 v93, 0x3f803f80, v4
    v_and_b32 v94, 0x3f803f80, v5
    v_and_b32 v95, 0x3f803f80, v6
    v_mov_b32 v22, 0
    v_mov_b32 v60, 0
    v_mov_b32 v61, 0
    v_mov_b32 v62, 0
    v_mov_b32 v63, 0
    v_mov_b32 v64, 0
    v_mov_b32 v65, 0
    v_mov_b32 v66, 0
    v_mov_b32 v67, 0
    v_mov_b32 v68, 0
    v_mov_b32 v69, 0
    v_mov_b32 v70, 0
    v_mov_b32 v71, 0
    v_mov_b32 v72, 0
    v_mov_b32 v73, 0
    v_mov_b32 v74, 0
    v_mov_b32 v75, 0
    v_mov_b32 v76, 0
    v_mov_b32 v77, 0
    v_mov_b32 v78, 0
    v_mov_b32 v79, 0
    v_mov_b32 v80, 0
    v_mov_b32 v81, 0
    v_mov_b32 v82, 0
    v_mov_b32 v83, 0
    v_mov_b32 v84, 0
    v_mov_b32 v85, 0
    v_mov_b32 v86, 0
    v_mov_b32 v87, 0
    v_mov_b32 v88, 0
    v_mov_b32 v89, 0
    v_mov_b32 v90, 0
    v_mov_b32 v91, 0
    s_mov_b32 s32, 1441792
    s_mov_b32 s33, 1445888
    s_mov_b32 s34, 1458176
    s_mov_b32 s35, 1462272
    s_mov_b32 s36, 1474560
    s_mov_b32 s37, 1478656
    s_mov_b32 s38, 1490944
    s_mov_b32 s39, 1495040
    s_mov_b32 s23, -1
    v_mov_b32 v24, 0x3f803f80
    s_branch L_Fg0
L_Floop:
    s_mov_b32 s25, 0
    s_mov_b32 exec_lo, 0xffffffff
    s_mov_b32 exec_hi, 0
L_gl_f:
    buffer_load_dword v54, v13, s[4:7], 0 offen sc1
    s_add_u32 s25, s25, 1
    s_cmp_gt_u32 s25, 20000
    s_cbranch_scc1 L_exit
    s_waitcnt vmcnt(0)
    v_cmp_ne_u32 vcc, -1, v54
    s_nop 0
    s_cbranch_vccz L_gl_f
L_gp_f:
    s_mov_b64 exec, s[28:29]
    s_cmp_eq_u32 s23, 0
    s_cbranch_scc1 L_gx_f
    buffer_load_dword v22, v17, s[4:7], 0 offen sc1
L_gx_f:
    buffer_load_dwordx4 v[60:63], v16, s[4:7], s32 offen sc1
    buffer_load_dwordx4 v[64:67], v16, s[4:7], s33 offen sc1
    buffer_load_dwordx4 v[68:71], v16, s[4:7], s34 offen sc1
    buffer_load_dwordx4 v[72:75], v16, s[4:7], s35 offen sc1
    buffer_load_dwordx4 v[76:79], v16, s[4:7], s36 offen sc1
    buffer_load_dwordx4 v[80:83], v16, s[4:7], s37 offen sc1
    buffer_load_dwordx4 v[84:87], v16, s[4:7], s38 offen sc1
    buffer_load_dwordx4 v[88:91], v16, s[4:7], s39 offen sc1
L_gc_f:
    s_mov_b64 exec, -1
    s_add_u32 s25, s25, 1
    s_cmp_gt_u32 s25, 20000
    s_cbranch_scc1 L_exit
    v_mov_b32 v42, 0
    v_mov_b32 v43, 0
    v_mov_b32 v44, 0
    v_mov_b32 v45, 0
    s_waitcnt vmcnt(6)
    s_nop 0
    v_smfmac_f32_16x16x64_bf16 v[42:45], v[92:95], v[60:67], v7
    v_max3_u32 v54, v22, v60, v64
    v_lshlrev_b32 v52, 16, v22
    v_and_b32 v53, 0xffff0000, v22
    s_waitcnt vmcnt(4)
    v_smfmac_f32_16x16x64_bf16 v[42:45], v[92:95], v[68:75], v7
    v_max3_u32 v54, v54, v68, v72
    s_waitcnt vmcnt(2)
    v_smfmac_f32_16x16x64_bf16 v[42:45], v[92:95], v[76:83], v7
    v_max3_u32 v54, v54, v76, v80
    s_waitcnt vmcnt(0)
    v_smfmac_f32_16x16x64_bf16 v[42:45], v[92:95], v[84:91], v7
    v_max3_u32 v54, v54, v84, v88
    v_cmp_eq_u32 vcc, -1, v54
    s_nop 0
    s_cbranch_vccnz L_gp_f
    s_nop 3
    v_cndmask_b32 v50, v42, v44, s[48:49]
    v_cndmask_b32 v51, v43, v45, s[48:49]
    v_cvt_pk_bf16_f32 v55, v50, v51
    v_lshlrev_b32 v50, 16, v55
    v_and_b32 v51, 0xffff0000, v55
    v_pk_add_f32 v[50:51], v[50:51], v[52:53]
    v_cvt_pk_bf16_f32 v24, v50, v51
    s_branch L_Fg
L_Fg0:
    s_waitcnt vmcnt(0)
    v_mov_b32 v22, v25
L_Fg:
    ds_write_b32 v18, v24
    v_lshlrev_b32 v50, 16, v24
    v_and_b32 v51, 0xffff0000, v24
    v_mov_b32 v42, 0
    v_mov_b32 v43, 0
    s_waitcnt lgkmcnt(0)
    ds_read_b128 v[26:29], v19
    ds_read_b128 v[30:33], v19 offset:16
    v_add_f32 v55, v50, v51
    v_mul_f32 v56, v50, v50
    v_fmac_f32 v56, v51, v51
    v_mov_b32 v44, 0
    v_mov_b32 v45, 0
    v_mov_b32 v46, 0
    v_mov_b32 v47, 0
    v_mov_b32 v48, 0
    v_mov_b32 v49, 0
    v_permlane32_swap_b32 v55, v56
    v_add_f32 v55, v55, v56
    s_and_b32 s26, s23, 1
    s_mul_i32 s26, s26, 4352
    v_add_u32 v8, s26, v20
    v_add_u32 v9, s26, v21
    s_waitcnt lgkmcnt(1)
    v_and_b32 v34, v26, v3
    v_and_b32 v35, v26, v4
    v_and_b32 v36, v26, v5
    v_and_b32 v37, v26, v6
    v_and_b32 v38, v27, v3
    v_and_b32 v39, v27, v4
    v_and_b32 v40, v27, v5
    v_and_b32 v41, v27, v6
    v_smfmac_f32_16x16x64_bf16 v[42:45], v[34:37], v[128:135], v7
    v_smfmac_f32_16x16x64_bf16 v[46:49], v[34:37], v[192:199], v7
    v_mov_b32 v56, v55
    v_and_b32 v34, v28, v3
    v_and_b32 v35, v28, v4
    v_and_b32 v36, v28, v5
    v_and_b32 v37, v28, v6
    v_smfmac_f32_16x16x64_bf16 v[42:45], v[38:41], v[136:143], v7
    v_smfmac_f32_16x16x64_bf16 v[46:49], v[38:41], v[200:207], v7
    v_and_b32 v38, v29, v3
    v_and_b32 v39, v29, v4
    v_and_b32 v40, v29, v5
    v_and_b32 v41, v29, v6
    v_smfmac_f32_16x16x64_bf16 v[42:45], v[34:37], v[144:151], v7
    v_smfmac_f32_16x16x64_bf16 v[46:49], v[34:37], v[208:215], v7
    v_permlane16_swap_b32 v55, v56
    v_add_f32 v55, v55, v56
    s_waitcnt lgkmcnt(0)
    v_and_b32 v34, v30, v3
    v_and_b32 v35, v30, v4
    v_and_b32 v36, v30, v5
    v_and_b32 v37, v30, v6
    v_smfmac_f32_16x16x64_bf16 v[42:45], v[38:41], v[152:159], v7
    v_smfmac_f32_16x16x64_bf16 v[46:49], v[38:41], v[216:223], v7
    v_add_f32_dpp v55, v55, v55 row_ror:8 row_mask:0xf bank_mask:0xf
    v_and_b32 v38, v31, v3
    v_and_b32 v39, v31, v4
    v_and_b32 v40, v31, v5
    v_and_b32 v41, v31, v6
    v_smfmac_f32_16x16x64_bf16 v[42:45], v[34:37], v[160:167], v7
    v_smfmac_f32_16x16x64_bf16 v[46:49], v[34:37], v[224:231], v7
    v_add_f32_dpp v55, v55, v55 row_ror:4 row_mask:0xf bank_mask:0xf
    v_and_b32 v34, v32, v3
    v_and_b32 v35, v32, v4
    v_and_b32 v36, v32, v5
    v_and_b32 v37, v32, v6
    v_smfmac_f32_16x16x64_bf16 v[42:45], v[38:41], v[168:175], v7
    v_smfmac_f32_16x16x64_bf16 v[46:49], v[38:41], v[232:239], v7
    v_add_f32_dpp v55, v55, v55 row_ror:2 row_mask:0xf bank_mask:0xf
    v_and_b32 v38, v33, v3
    v_and_b32 v39, v33, v4
    v_and_b32 v40, v33, v5
    v_and_b32 v41, v33, v6
    v_smfmac_f32_16x16x64_bf16 v[42:45], v[34:37], v[176:183], v7
    v_smfmac_f32_16x16x64_bf16 v[46:49], v[34:37], v[240:247], v7
    v_add_f32_dpp v55, v55, v55 row_ror:1 row_mask:0xf bank_mask:0xf
    v_smfmac_f32_16x16x64_bf16 v[42:45], v[38:41], v[184:191], v7
    v_smfmac_f32_16x16x64_bf16 v[46:49], v[38:41], v[248:255], v7
    s_mov_b32 exec_lo, 1
    s_mov_b32 exec_hi, 1
    ds_write_b32 v9, v55
    s_mov_b64 exec, s[50:51]
    s_nop 2
    ds_write_b128 v8, v[42:45]
    ds_write_b128 v8, v[46:49] offset:2048
    s_mov_b64 exec, -1
    s_waitcnt lgkmcnt(0)
    s_barrier
    s_cmp_eq_u32 s23, -1
    s_cbranch_scc0 L_Fn1
    v_mov_b32 v8, 12288
    ds_read_b32 v9, v8
    s_waitcnt lgkmcnt(0)
    v_readfirstlane_b32 s20, v9
    v_add_u32 v16, v9, v16
    v_add_u32 v17, v9, v17
    v_add_u32 v13, v9, v13
    s_mov_b32 s23, 0
    s_branch L_Floop
L_Fn1:
    s_cmp_eq_u32 s21, 0
    s_cbranch_scc0 L_Fnx
    v_subrev_u32 v8, s20, v17
    v_min_u32 v9, -2, v24
    s_lshl_b32 s26, s23, 14
    s_add_u32 s26, s26, 147456
    v_add_u32 v8, s26, v8
    s_mov_b32 s26, 8192
    s_mov_b64 exec, s[28:29]
    buffer_store_dword v9, v8, s[4:7], 0 offen sc1
    buffer_store_dword v9, v8, s[4:7], s26 offen sc1
    s_mov_b64 exec, -1
L_Fnx:
    v_add_u32 v16, 65536, v16
    v_add_u32 v13, 65536, v13
    s_add_u32 s23, s23, 1
    s_cmp_lt_i32 s23, 2
    s_cbranch_scc1 L_Floop
    s_branch L_exit
L_Fb:
    s_sub_u32 s30, s22, 4
    s_mul_i32 s27, s21, 57344
    s_add_u32 s8, s80, s27
    s_addc_u32 s9, s81, 0
    s_mov_b32 s10, 57344
    s_mov_b32 s11, 0x20000
    s_lshr_b32 s27, s21, 3
    s_lshl_b32 s27, s27, 14
    s_and_b32 s26, s21, 7
    s_lshl_b32 s26, s26, 10
    s_add_u32 s52, s26, s27
    s_add_u32 s52, s52, 1589248
    s_cmp_eq_u32 s22, 4
    s_cbranch_scc0 L_Fb1
    v_mov_b32 v8, 0
    buffer_load_dword v9, v8, s[4:7], 0 offen sc1
    v_mov_b32 v12, -1
    v_mov_b32 v13, -1
    v_mov_b32 v14, -1
    v_mov_b32 v15, -1
    v_lshlrev_b32 v10, 4, v0
    buffer_store_dwordx4 v[12:15], v10, s[4:7], s52 offen sc1
    s_add_u32 s31, s52, 8192
    buffer_store_dwordx4 v[12:15], v10, s[4:7], s31 offen sc1
    s_add_u32 s53, s52, 65536
    buffer_store_dwordx4 v[12:15], v10, s[4:7], s53 offen sc1
    s_add_u32 s31, s53, 8192
    buffer_store_dwordx4 v[12:15], v10, s[4:7], s31 offen sc1
    s_cmp_eq_u32 s21, 0
    s_cbranch_scc0 L_Fb1
    s_mov_b32 s53, 1720320
    buffer_store_dwordx4 v[12:15], v10, s[4:7], s53 offen sc1
    s_add_u32 s31, s53, 8192
    buffer_store_dwordx4 v[12:15], v10, s[4:7], s31 offen sc1
    s_mov_b32 s53, 1736704
    buffer_store_dwordx4 v[12:15], v10, s[4:7], s53 offen sc1
    s_add_u32 s31, s53, 8192
    buffer_store_dwordx4 v[12:15], v10, s[4:7], s31 offen sc1
L_Fb1:
    v_lshrrev_b32 v20, 1, v2
    v_mul_u32_u24 v20, 16, v20
    v_and_b32 v21, 1, v2
    v_add_u32 v20, v20, v21
    v_mul_u32_u24 v20, 896, v20
    v_lshl_add_u32 v20, v1, 4, v20
    s_lshl_b32 s26, s30, 8
    v_add_u32 v16, s26, v20
    s_cmp_eq_u32 s30, 3
    s_cselect_b32 s28, 0x00ff00ff, -1
    s_mov_b32 s29, s28
    s_mov_b64 exec, s[28:29]
    s_mov_b32 s26, 0
    s_waitcnt vmcnt(0)
    buffer_load_dwordx4 v[128:131], v16, s[8:11], s26 offen nt
    s_mov_b32 s26, 28672
    s_waitcnt vmcnt(0)
    buffer_load_dwordx4 v[132:135], v16, s[8:11], s26 offen nt
    s_mov_b32 s26, 1792
    buffer_load_dwordx4 v[136:139], v16, s[8:11], s26 offen nt
    s_mov_b32 s26, 30464
    buffer_load_dwordx4 v[140:143], v16, s[8:11], s26 offen nt
    s_mov_b32 s26, 3584
    buffer_load_dwordx4 v[144:147], v16, s[8:11], s26 offen nt
    s_mov_b32 s26, 32256
    buffer_load_dwordx4 v[148:151], v16, s[8:11], s26 offen nt
    s_mov_b32 s26, 5376
    buffer_load_dwordx4 v[152:155], v16, s[8:11], s26 offen nt
    s_mov_b32 s26, 34048
    buffer_load_dwordx4 v[156:159], v16, s[8:11], s26 offen nt
    s_mov_b32 s26, 7168
    buffer_load_dwordx4 v[160:163], v16, s[8:11], s26 offen nt
    s_mov_b32 s26, 35840
    buffer_load_dwordx4 v[164:167], v16, s[8:11], s26 offen nt
    s_mov_b32 s26, 8960
    buffer_load_dwordx4 v[168:171], v16, s[8:11], s26 offen nt
    s_mov_b32 s26, 37632
    buffer_load_dwordx4 v[172:175], v16, s[8:11], s26 offen nt
    s_mov_b32 s26, 10752
    buffer_load_dwordx4 v[176:179], v16, s[8:11], s26 offen nt
    s_mov_b32 s26, 39424
    buffer_load_dwordx4 v[180:183], v16, s[8:11], s26 offen nt
    s_mov_b32 s26, 12544
    buffer_load_dwordx4 v[184:187], v16, s[8:11], s26 offen nt
    s_mov_b32 s26, 41216
    buffer_load_dwordx4 v[188:191], v16, s[8:11], s26 offen nt
    s_mov_b64 exec, -1
    s_cmp_eq_u32 s22, 4
    s_cbranch_scc0 L_Fb2
    s_waitcnt vmcnt(16)
    v_readfirstlane_b32 s24, v9
    s_nop 0
    s_mul_i32 s24, s24, 0x9E3779B1
    s_add_u32 s24, s24, 0x7F4A7C15
    s_lshr_b32 s26, s2, 7
    s_lshl_b32 s26, s26, 14
    s_and_b32 s27, s2, 127
    s_lshl_b32 s27, s27, 6
    s_add_u32 s26, s26, s27
    s_add_u32 s26, s26, 16384
    v_mov_b32 v8, 0
    v_mov_b32 v11, s24
    s_mov_b64 exec, 1
    buffer_store_dword v11, v8, s[4:7], s26 offen sc1
    s_mov_b64 exec, -1
    s_mov_b32 s27, 193
    v_add_u32 v8, s27, v0
    v_cmp_eq_u32 vcc, 32, v0
    v_mov_b32 v11, 1
    s_nop 0
    v_cndmask_b32 v8, v8, v11, vcc
    v_cmp_ne_u32 vcc, 33, v0
    s_nop 1
    v_cndmask_b32 v8, 0, v8, vcc
    v_cndmask_b32_e64 v9, 1, 0, vcc
    v_lshrrev_b32 v11, 7, v8
    v_lshlrev_b32 v11, 14, v11
    v_and_b32 v8, 127, v8
    v_lshl_add_u32 v8, v8, 6, v11
    s_mov_b32 s26, 16384
    s_mov_b32 s25, 0
    s_mov_b32 exec_lo, 0xffffffff
    s_mov_b32 exec_hi, 0x3
L_fp_f:
    buffer_load_dword v11, v8, s[4:7], s26 offen sc1
    s_add_u32 s25, s25, 1
    s_cmp_gt_u32 s25, 20000
    s_cbranch_scc1 L_exit
    s_waitcnt vmcnt(0)
    v_xor_b32 v11, s24, v11
    v_cmp_gt_u32 vcc, v11, v9
    s_nop 0
    s_cbranch_vccnz L_fp_f
    v_readlane_b32 s26, v11, 33
    s_mov_b64 exec, -1
    s_lshl_b32 s26, s26, 13
    s_xor_b32 s20, s20, s26
    v_mov_b32 v8, 12288
    v_mov_b32 v9, s20
    ds_write_b32 v8, v9
    s_waitcnt lgkmcnt(0)
L_Fb2:
    v_and_b32 v8, 4, v1
    v_cmp_eq_u32 vcc, 0, v8
    v_mov_b32 v9, 0xffff
    s_nop 0
    v_cndmask_b32 v3, 0, v9, vcc
    v_xor_b32 v4, v3, v9
    v_lshlrev_b32 v5, 16, v3
    v_lshlrev_b32 v6, 16, v4
    v_and_b32 v8, 3, v1
    v_mul_u32_u24 v7, 17425, v8
    v_xor_b32 v8, 1, v8
    v_mul_u32_u24 v8, 4420, v8
    v_add_u32 v7, v7, v8
    v_lshrrev_b32 v9, 1, v2
    v_lshlrev_b32 v9, 13, v9
    v_lshl_add_u32 v8, v1, 4, v9
    s_lshl_b32 s26, s30, 8
    s_add_u32 s26, s26, s52
    v_add_u32 v17, s26, v8
    s_and_b32 s46, s28, 0xffff
    s_mov_b32 s47, s46
    v_lshlrev_b32 v58, 2, v0
    v_add_u32 v58, 1024, v58
    s_lshl_b32 s26, s30, 7
    s_add_u32 s26, s26, 10240
    v_lshl_add_u32 v18, v0, 1, s26
    v_lshl_add_u32 v19, v2, 5, s26
    s_mov_b32 s23, -1
L_Fbl:
    s_and_b32 s26, s23, 1
    s_mul_i32 s26, s26, 4352
    v_add_u32 v10, s26, v58
    s_add_u32 s26, s26, 5120
    v_mov_b32 v11, s26
    s_lshl_b32 s27, s23, 16
    s_barrier
    ds_read_b128 v[76:79], v11
    ds_read_b128 v[80:83], v11 offset:16
    ds_read2st64_b32 v[60:61], v10 offset0:0 offset1:1
    ds_read2st64_b32 v[62:63], v10 offset0:2 offset1:3
    ds_read2st64_b32 v[64:65], v10 offset0:4 offset1:5
    ds_read2st64_b32 v[66:67], v10 offset0:6 offset1:7
    ds_read2st64_b32 v[68:69], v10 offset0:8 offset1:9
    ds_read2st64_b32 v[70:71], v10 offset0:10 offset1:11
    ds_read2st64_b32 v[72:73], v10 offset0:12 offset1:13
    ds_read2st64_b32 v[74:75], v10 offset0:14 offset1:15
    s_waitcnt lgkmcnt(8)
    v_pk_add_f32 v[76:77], v[76:77], v[78:79]
    v_pk_add_f32 v[80:81], v[80:81], v[82:83]
    v_pk_add_f32 v[76:77], v[76:77], v[80:81]
    v_mul_f32 v76, 0x3b124925, v76
    v_mul_f32 v77, 0x3b124925, v77
    v_fma_f32 v77, -v76, v76, v77
    v_max_f32 v77, 0, v77
    v_cvt_pk_bf16_f32 v78, v76, v77
    v_lshlrev_b32 v76, 16, v78
    v_and_b32 v77, 0xffff0000, v78
    v_add_f32 v77, 0x3727c5ac, v77
    v_cvt_pk_bf16_f32 v77, v77, v77
    v_and_b32 v77, 0xffff0000, v77
    v_sqrt_f32 v77, v77
    s_nop 0
    v_cvt_pk_bf16_f32 v77, v77, v77
    v_and_b32 v77, 0xffff0000, v77
    v_rcp_f32 v77, v77
    s_waitcnt lgkmcnt(4)
    v_pk_add_f32 v[60:61], v[60:61], v[62:63]
    v_pk_add_f32 v[64:65], v[64:65], v[66:67]
    v_pk_add_f32 v[60:61], v[60:61], v[64:65]
    v_add_f32 v60, v60, v61
    s_waitcnt lgkmcnt(0)
    v_pk_add_f32 v[68:69], v[68:69], v[70:71]
    v_pk_add_f32 v[72:73], v[72:73], v[74:75]
    v_pk_add_f32 v[68:69], v[68:69], v[72:73]
    v_add_f32 v68, v68, v69
    s_cmp_eq_u32 s23, -1
    s_cbranch_scc0 L_Fbh
    v_mov_b32 v56, v60
    v_mov_b32 v57, v68
    s_mov_b32 s23, 0
    s_branch L_Fbl
L_Fbh:
    v_fma_f32 v60, -v76, v56, v60
    v_fma_f32 v68, -v76, v57, v68
    v_mul_f32 v60, v60, v77
    v_mul_f32 v68, v68, v77
    v_cvt_pk_bf16_f32 v61, v60, v68
    v_lshlrev_b32 v60, 16, v61
    v_and_b32 v68, 0xffff0000, v61
    v_mul_f32 v61, 0xbfb8aa3b, v60
    v_exp_f32 v61, v61
    s_nop 0
    v_add_f32 v61, 1.0, v61
    v_rcp_f32 v61, v61
    s_nop 0
    v_mul_f32 v61, v60, v61
    v_cvt_pk_bf16_f32 v61, v61, v61
    v_and_b32 v61, 0xffff0000, v61
    v_mul_f32 v61, v61, v68
    s_nop 1
    v_mov_b32_dpp v62, v61 quad_perm:[1,0,3,2] row_mask:0xf bank_mask:0xf
    v_cvt_pk_bf16_f32 v26, v61, v62
    s_waitcnt vmcnt(0)
    v_mov_b32 v42, 0
    v_mov_b32 v43, 0
    v_mov_b32 v44, 0
    v_mov_b32 v45, 0
    v_and_b32_dpp v34, v26, v3 row_newbcast:0 row_mask:0xf bank_mask:0xf
    v_and_b32_dpp v35, v26, v4 row_newbcast:0 row_mask:0xf bank_mask:0xf
    v_and_b32_dpp v36, v26, v5 row_newbcast:0 row_mask:0xf bank_mask:0xf
    v_and_b32_dpp v37, v26, v6 row_newbcast:0 row_mask:0xf bank_mask:0xf
    v_and_b32_dpp v38, v26, v3 row_newbcast:2 row_mask:0xf bank_mask:0xf
    v_and_b32_dpp v39, v26, v4 row_newbcast:2 row_mask:0xf bank_mask:0xf
    v_and_b32_dpp v40, v26, v5 row_newbcast:2 row_mask:0xf bank_mask:0xf
    v_and_b32_dpp v41, v26, v6 row_newbcast:2 row_mask:0xf bank_mask:0xf
    v_smfmac_f32_16x16x64_bf16 v[42:45], v[34:37], v[128:135], v7
    v_and_b32_dpp v34, v26, v3 row_newbcast:4 row_mask:0xf bank_mask:0xf
    v_and_b32_dpp v35, v26, v4 row_newbcast:4 row_mask:0xf bank_mask:0xf
    v_and_b32_dpp v36, v26, v5 row_newbcast:4 row_mask:0xf bank_mask:0xf
    v_and_b32_dpp v37, v26, v6 row_newbcast:4 row_mask:0xf bank_mask:0xf
    v_smfmac_f32_16x16x64_bf16 v[42:45], v[38:41], v[136:143], v7
    v_and_b32_dpp v38, v26, v3 row_newbcast:6 row_mask:0xf bank_mask:0xf
    v_and_b32_dpp v39, v26, v4 row_newbcast:6 row_mask:0xf bank_mask:0xf
    v_and_b32_dpp v40, v26, v5 row_newbcast:6 row_mask:0xf bank_mask:0xf
    v_and_b32_dpp v41, v26, v6 row_newbcast:6 row_mask:0xf bank_mask:0xf
    v_smfmac_f32_16x16x64_bf16 v[42:45], v[34:37], v[144:151], v7
    v_and_b32_dpp v34, v26, v3 row_newbcast:8 row_mask:0xf bank_mask:0xf
    v_and_b32_dpp v35, v26, v4 row_newbcast:8 row_mask:0xf bank_mask:0xf
    v_and_b32_dpp v36, v26, v5 row_newbcast:8 row_mask:0xf bank_mask:0xf
    v_and_b32_dpp v37, v26, v6 row_newbcast:8 row_mask:0xf bank_mask:0xf
    v_smfmac_f32_16x16x64_bf16 v[42:45], v[38:41], v[152:159], v7
    v_and_b32_dpp v38, v26, v3 row_newbcast:10 row_mask:0xf bank_mask:0xf
    v_and_b32_dpp v39, v26, v4 row_newbcast:10 row_mask:0xf bank_mask:0xf
    v_and_b32_dpp v40, v26, v5 row_newbcast:10 row_mask:0xf bank_mask:0xf
    v_and_b32_dpp v41, v26, v6 row_newbcast:10 row_mask:0xf bank_mask:0xf
    v_smfmac_f32_16x16x64_bf16 v[42:45], v[34:37], v[160:167], v7
    v_and_b32_dpp v34, v26, v3 row_newbcast:12 row_mask:0xf bank_mask:0xf
    v_and_b32_dpp v35, v26, v4 row_newbcast:12 row_mask:0xf bank_mask:0xf
    v_and_b32_dpp v36, v26, v5 row_newbcast:12 row_mask:0xf bank_mask:0xf
    v_and_b32_dpp v37, v26, v6 row_newbcast:12 row_mask:0xf bank_mask:0xf
    v_smfmac_f32_16x16x64_bf16 v[42:45], v[38:41], v[168:175], v7
    v_and_b32_dpp v38, v26, v3 row_newbcast:14 row_mask:0xf bank_mask:0xf
    v_and_b32_dpp v39, v26, v4 row_newbcast:14 row_mask:0xf bank_mask:0xf
    v_and_b32_dpp v40, v26, v5 row_newbcast:14 row_mask:0xf bank_mask:0xf
    v_and_b32_dpp v41, v26, v6 row_newbcast:14 row_mask:0xf bank_mask:0xf
    v_smfmac_f32_16x16x64_bf16 v[42:45], v[34:37], v[176:183], v7
    s_nop 0
    v_smfmac_f32_16x16x64_bf16 v[42:45], v[38:41], v[184:191], v7
    s_nop 7
    v_cvt_pk_bf16_f32 v46, v42, v43
    v_cvt_pk_bf16_f32 v48, v42, v43
    v_cvt_pk_bf16_f32 v47, v44, v45
    v_cvt_pk_bf16_f32 v49, v44, v45
    v_permlane16_swap_b32 v46, v48
    s_nop 0
    v_permlane16_swap_b32 v47, v49
    s_mov_b64 exec, s[46:47]
    v_min_u32 v46, -2, v46
    buffer_store_dwordx4 v[46:49], v17, s[4:7], s27 offen sc1
    s_mov_b64 exec, -1
    s_add_u32 s23, s23, 1
    s_cmp_lt_i32 s23, 2
    s_cbranch_scc1 L_Fbl
    s_branch L_exit
L_exit:
    s_waitcnt lgkmcnt(0)
L_end:
s_endpgm
.section .rodata,"a"
.p2align 6
.amdhsa_kernel interleave_layers__sliding_block_cached__glu_gated_swiglu__decode_kernel
  .amdhsa_next_free_vgpr 256
  .amdhsa_next_free_sgpr 102
  .amdhsa_accum_offset 256
  .amdhsa_group_segment_fixed_size 0
  .amdhsa_kernarg_size 96
  .amdhsa_user_sgpr_count 2
  .amdhsa_user_sgpr_kernarg_segment_ptr 1
  .amdhsa_system_sgpr_workgroup_id_x 1
.end_amdhsa_kernel
```
